```python
import torch

def _softmax(x, axis=-1):
    return torch.softmax(x, dim=axis)
def _gelu(x):
    return torch.nn.functional.gelu(x, approximate="tanh")
def _silu(x):
    return torch.nn.functional.silu(x)
def _sigmoid(x):
    return torch.sigmoid(x)
def _layernorm(x, axis=-1, eps=1e-5):
    m = x.mean(dim=axis, keepdim=True)
    v = x.var(dim=axis, keepdim=True, unbiased=False)
    return (x - m) / torch.sqrt(v + eps)
def _scatter_add(tgt, idx, src, axis=0):
    return tgt.clone().index_add_(axis, idx, src)
def _segment_sum(src, seg, n):
    out = torch.zeros((n,) + src.shape[1:], dtype=src.dtype)
    return out.index_add_(0, seg, src)
def _pad(x, pw):
    flat = tuple(v for pair in reversed(pw) for v in pair)
    return torch.nn.functional.pad(x, flat)

kernel_name = 'standalone__normalfloat_lut_codebook_lookup__prompt'

def setup_inputs():

    _w = (lambda a: (lambda t: t.to(torch.bfloat16) if t.is_floating_point() else t)(torch.as_tensor(a)))
    B, S, D, F = 1, 2048, 576, 4608
    G = -1 if -1 > 0 else D
    D = (D // G) * G
    ng = D // G
    nf4 = torch.tensor([
        -1.0, -0.6961928009986877, -0.5250730514526367, -0.39491748809814453,
        -0.28444138169288635, -0.18477343022823334, -0.09105003625154495, 0.0,
        0.07958029955625534, 0.16093020141124725, 0.24611230194568634, 0.33791524171829224,
        0.44070982933044434, 0.5626170039176941, 0.7229568362236023, 1.0
    ], dtype=float)
    qw = torch.randint(0, 16, (D, F)).to(torch.int64)
    absmax = (torch.abs((lambda *s: torch.randn(*s, dtype=torch.bfloat16) * 0.05)(ng, F)) + 0.01).to(float)
    return {
        "x": _w((lambda *s: torch.randn(*s, dtype=torch.bfloat16) * 0.05)(B, S, D)),
        "qw": _w(qw),
        "codebook": _w(nf4),
        "absmax": _w(absmax),
    }

def reference(x, qw, codebook, absmax):
    B, S, D = x.shape
    ng, F = absmax.shape
    G = D // ng
    w_nf = codebook[qw]
    s = (lambda x, n, axis: torch.repeat_interleave(x, n, dim=axis))(absmax, G, axis=0)
    w = (lambda x, dt: x.to(dt))(w_nf * s, x.dtype)
    return torch.einsum("bsd,df->bsf", x, w)
```

```asm
; @launch grid=(256,1,1) block=(512,1,1) lds=163840
.amdgcn_target "amdgcn-amd-amdhsa--gfx950"
.text
.globl standalone__normalfloat_lut_codebook_lookup__prompt_kernel
.p2align 8
.type standalone__normalfloat_lut_codebook_lookup__prompt_kernel,@function
standalone__normalfloat_lut_codebook_lookup__prompt_kernel:
    s_cmp_ge_u32 s2, 256
    s_cbranch_scc1 L_end
    s_load_dwordx4 s[4:7], s[0:1], 0
    s_load_dwordx4 s[8:11], s[0:1], 16
    s_load_dwordx2 s[12:13], s[0:1], 32
    s_and_b32 s42, s2, 7
    s_lshl_b32 s42, s42, 5
    s_lshr_b32 s43, s2, 3
    s_add_u32 s42, s42, s43
    s_cmp_ge_u32 s42, 252
    s_cbranch_scc1 L_end
    s_mul_i32 s36, s42, 293
    s_lshr_b32 s36, s36, 11
    s_mul_i32 s43, s36, 7
    s_sub_u32 s37, s42, s43
    s_mul_i32 s38, s37, 18
    s_min_u32 s43, s37, 2
    s_add_u32 s38, s38, s43
    v_lshrrev_b32 v1, 6, v0
    v_and_b32 v0, 63, v0
    v_readfirstlane_b32 s40, v1
    s_nop 3
    s_cmp_ge_u32 s40, 4
    s_cbranch_scc0 L_consumer
L_producer:
    v_mov_b32 v100, v0
    s_sub_u32 s42, s40, 4
    s_and_b32 s56, s42, 1
    s_lshr_b32 s57, s42, 1
    s_mul_i32 s43, s37, 0
    s_mul_i32 s54, s36, 0
    s_add_u32 s43, s43, s54
    s_mul_i32 s54, s43, 7282
    s_lshr_b32 s54, s54, 16
    s_mul_i32 s54, s54, 9
    s_sub_u32 s43, s43, s54
    s_add_u32 s52, s38, s57
    s_mul_i32 s52, s52, 18432
    s_cmp_lt_u32 s37, 2
    s_cselect_b32 s39, 1, 0
    s_cmp_eq_u32 s57, 0
    s_cselect_b32 s39, s39, 0
    s_lshl_b32 s54, s43, 7
    s_add_u32 s72, s52, s54
    s_mul_i32 s81, s43, 1179648
    s_lshl_b32 s54, s42, 4
    s_mul_i32 s54, s54, 18432
    s_lshl_b32 s55, s36, 9
    s_add_u32 s54, s54, s55
    v_lshrrev_b32 v1, 5, v100
    v_mul_u32_u24 v2, 147456, v1
    v_and_b32 v3, 31, v100
    v_lshl_add_u32 v2, v3, 4, v2
    v_add_u32 v96, s54, v2
    s_mov_b32 s44, 0
    s_mov_b32 s45, 18432
    s_mov_b32 s46, 36864
    s_mov_b32 s47, 55296
    s_mov_b32 s48, 73728
    s_mov_b32 s49, 92160
    s_mov_b32 s50, 110592
    s_mov_b32 s51, 129024
    v_lshrrev_b32 v4, 3, v100
    s_lshl_b32 s55, s56, 3
    v_add_u32 v4, s55, v4
    v_lshrrev_b32 v5, 1, v4
    v_and_b32 v6, 7, v100
    v_xor_b32 v5, v5, v6
    v_lshlrev_b32 v5, 4, v5
    v_mul_u32_u24 v4, 1152, v4
    v_add_u32 v97, v4, v5
    s_lshl_b32 s53, s56, 10
    s_lshl_b32 s55, s57, 11
    s_add_u32 s53, s53, s55
    s_lshl_b32 s41, s56, 10
    s_add_u32 s41, s41, 110592
    v_add_u32 v101, s81, v96
    s_waitcnt lgkmcnt(0)
    s_mov_b32 s20, s6
    s_and_b32 s21, s7, 0xffff
    s_mov_b32 s22, 10616832
    s_mov_b32 s23, 0x20000
    buffer_load_dwordx4 v[0:3], v101, s[20:23], s44 offen
    buffer_load_dwordx4 v[4:7], v101, s[20:23], s45 offen
    buffer_load_dwordx4 v[8:11], v101, s[20:23], s46 offen
    buffer_load_dwordx4 v[12:15], v101, s[20:23], s47 offen
    buffer_load_dwordx4 v[16:19], v101, s[20:23], s48 offen
    buffer_load_dwordx4 v[20:23], v101, s[20:23], s49 offen
    buffer_load_dwordx4 v[24:27], v101, s[20:23], s50 offen
    buffer_load_dwordx4 v[28:31], v101, s[20:23], s51 offen
    s_mov_b32 s16, s4
    s_and_b32 s17, s5, 0xffff
    s_mov_b32 s18, 2359296
    s_mov_b32 s19, 0x20000
    s_add_u32 m0, s53, 0
    s_add_u32 s66, s72, 0
    buffer_load_dwordx4 v97, s[16:19], s66 offen lds
    s_add_u32 m0, s53, 4096
    s_add_u32 s66, s72, 36864
    buffer_load_dwordx4 v97, s[16:19], s66 offen lds
    s_add_u32 m0, s53, 8192
    s_add_u32 s66, s72, 73728
    buffer_load_dwordx4 v97, s[16:19], s66 offen lds
    s_add_u32 m0, s53, 12288
    s_add_u32 s66, s72, 110592
    buffer_load_dwordx4 v97, s[16:19], s66 offen lds
    s_add_u32 m0, s53, 16384
    s_add_u32 s66, s72, 147456
    buffer_load_dwordx4 v97, s[16:19], s66 offen lds
    s_add_u32 m0, s53, 20480
    s_add_u32 s66, s72, 184320
    buffer_load_dwordx4 v97, s[16:19], s66 offen lds
    s_add_u32 m0, s53, 24576
    s_add_u32 s66, s72, 221184
    buffer_load_dwordx4 v97, s[16:19], s66 offen lds
    s_add_u32 m0, s53, 28672
    s_add_u32 s66, s72, 258048
    buffer_load_dwordx4 v97, s[16:19], s66 offen lds
    s_add_u32 m0, s53, 32768
    s_add_u32 s66, s72, 294912
    buffer_load_dwordx4 v97, s[16:19], s66 offen lds
    s_cmp_eq_u32 s39, 1
    s_cbranch_scc0 L_sk1
    s_add_u32 m0, s41, 0
    s_add_u32 s66, s72, 331776
    buffer_load_dwordx4 v97, s[16:19], s66 offen lds
L_sk1:
    s_add_u32 s43, s43, 1
    s_cmp_eq_u32 s43, 9
    s_cselect_b32 s43, 0, s43
    s_lshl_b32 s54, s43, 7
    s_add_u32 s73, s52, s54
    s_mul_i32 s82, s43, 1179648
    s_add_u32 s43, s43, 1
    s_cmp_eq_u32 s43, 9
    s_cselect_b32 s43, 0, s43
    s_lshl_b32 s54, s43, 7
    s_add_u32 s74, s52, s54
    s_mul_i32 s83, s43, 1179648
    s_add_u32 s43, s43, 1
    s_cmp_eq_u32 s43, 9
    s_cselect_b32 s43, 0, s43
    s_lshl_b32 s54, s43, 7
    s_add_u32 s75, s52, s54
    s_mul_i32 s84, s43, 1179648
    s_add_u32 s43, s43, 1
    s_cmp_eq_u32 s43, 9
    s_cselect_b32 s43, 0, s43
    s_lshl_b32 s54, s43, 7
    s_add_u32 s76, s52, s54
    s_mul_i32 s85, s43, 1179648
    s_add_u32 s43, s43, 1
    s_cmp_eq_u32 s43, 9
    s_cselect_b32 s43, 0, s43
    s_lshl_b32 s54, s43, 7
    s_add_u32 s77, s52, s54
    s_mul_i32 s86, s43, 1179648
    s_add_u32 s43, s43, 1
    s_cmp_eq_u32 s43, 9
    s_cselect_b32 s43, 0, s43
    s_lshl_b32 s54, s43, 7
    s_add_u32 s78, s52, s54
    s_mul_i32 s87, s43, 1179648
    s_add_u32 s43, s43, 1
    s_cmp_eq_u32 s43, 9
    s_cselect_b32 s43, 0, s43
    s_lshl_b32 s54, s43, 7
    s_add_u32 s79, s52, s54
    s_mul_i32 s88, s43, 1179648
    s_add_u32 s43, s43, 1
    s_cmp_eq_u32 s43, 9
    s_cselect_b32 s43, 0, s43
    s_lshl_b32 s54, s43, 7
    s_add_u32 s80, s52, s54
    s_mul_i32 s89, s43, 1179648
    v_and_b32 v98, 31, v100
    v_lshrrev_b32 v102, 4, v98
    v_and_b32 v103, 15, v98
    v_lshlrev_b32 v103, 4, v103
    v_lshl_add_u32 v103, v102, 12, v103
    v_lshrrev_b32 v102, 5, v100
    v_lshl_add_u32 v103, v102, 8, v103
    s_lshl_b32 s55, s56, 9
    s_lshl_b32 s54, s57, 13
    s_add_u32 s55, s55, s54
    s_add_u32 s55, s55, 114688
    v_add_u32 v99, s55, v103
    v_and_b32 v98, 15, v98
    v_lshlrev_b32 v98, 2, v98
    v_add_u32 v98, 147456, v98
    s_barrier
    s_waitcnt vmcnt(9)
    v_add_u32 v101, s82, v96
    buffer_load_dwordx4 v[32:35], v101, s[20:23], s44 offen
    v_lshl_add_u32 v0, v0, 6, v98
    v_lshl_add_u32 v8, v8, 6, v98
    v_lshl_add_u32 v16, v16, 6, v98
    v_lshl_add_u32 v24, v24, 6, v98
    v_lshl_add_u32 v1, v1, 6, v98
    v_lshl_add_u32 v9, v9, 6, v98
    v_lshl_add_u32 v17, v17, 6, v98
    buffer_load_dwordx4 v[36:39], v101, s[20:23], s45 offen
    v_lshl_add_u32 v25, v25, 6, v98
    v_lshl_add_u32 v0, v4, 10, v0
    v_lshl_add_u32 v8, v12, 10, v8
    v_lshl_add_u32 v16, v20, 10, v16
    v_lshl_add_u32 v24, v28, 10, v24
    v_lshl_add_u32 v1, v5, 10, v1
    v_lshl_add_u32 v9, v13, 10, v9
    buffer_load_dwordx4 v[40:43], v101, s[20:23], s46 offen
    v_lshl_add_u32 v17, v21, 10, v17
    v_lshl_add_u32 v25, v29, 10, v25
    v_lshl_add_u32 v2, v2, 6, v98
    v_lshl_add_u32 v10, v10, 6, v98
    v_lshl_add_u32 v18, v18, 6, v98
    v_lshl_add_u32 v26, v26, 6, v98
    v_lshl_add_u32 v3, v3, 6, v98
    buffer_load_dwordx4 v[44:47], v101, s[20:23], s47 offen
    v_lshl_add_u32 v11, v11, 6, v98
    v_lshl_add_u32 v19, v19, 6, v98
    v_lshl_add_u32 v27, v27, 6, v98
    v_lshl_add_u32 v2, v6, 10, v2
    v_lshl_add_u32 v10, v14, 10, v10
    v_lshl_add_u32 v18, v22, 10, v18
    v_lshl_add_u32 v26, v30, 10, v26
    buffer_load_dwordx4 v[48:51], v101, s[20:23], s48 offen
    v_lshl_add_u32 v3, v7, 10, v3
    v_lshl_add_u32 v11, v15, 10, v11
    v_lshl_add_u32 v19, v23, 10, v19
    v_lshl_add_u32 v27, v31, 10, v27
    ds_read_b32 v4, v0
    ds_read_b32 v5, v8
    ds_read_b32 v6, v16
    buffer_load_dwordx4 v[52:55], v101, s[20:23], s49 offen
    ds_read_b32 v7, v24
    ds_read_b32 v12, v1
    ds_read_b32 v13, v9
    ds_read_b32 v14, v17
    ds_read_b32 v15, v25
    ds_read_b32 v20, v2
    ds_read_b32 v21, v10
    buffer_load_dwordx4 v[56:59], v101, s[20:23], s50 offen
    ds_read_b32 v22, v18
    ds_read_b32 v23, v26
    ds_read_b32 v28, v3
    ds_read_b32 v29, v11
    ds_read_b32 v30, v19
    ds_read_b32 v31, v27
    s_waitcnt lgkmcnt(12)
    buffer_load_dwordx4 v[60:63], v101, s[20:23], s51 offen
    ds_write_b128 v99, v[4:7] offset:0
    s_waitcnt lgkmcnt(9)
    ds_write_b128 v99, v[12:15] offset:1024
    s_waitcnt lgkmcnt(6)
    ds_write_b128 v99, v[20:23] offset:2048
    s_waitcnt lgkmcnt(3)
    ds_write_b128 v99, v[28:31] offset:3072
    s_waitcnt vmcnt(8)
    s_waitcnt lgkmcnt(0)
    s_barrier
    s_cmp_eq_u32 s39, 1
    s_cbranch_scc0 L_sk2
    s_add_u32 m0, s41, 2048
    s_add_u32 s66, s73, 331776
    buffer_load_dwordx4 v97, s[16:19], s66 offen lds
L_sk2:
    s_add_u32 m0, s53, 36864
    s_add_u32 s66, s73, 0
    buffer_load_dwordx4 v97, s[16:19], s66 offen lds
    s_add_u32 m0, s53, 40960
    s_add_u32 s66, s73, 36864
    buffer_load_dwordx4 v97, s[16:19], s66 offen lds
    s_add_u32 m0, s53, 45056
    s_add_u32 s66, s73, 73728
    buffer_load_dwordx4 v97, s[16:19], s66 offen lds
    s_add_u32 m0, s53, 49152
    s_add_u32 s66, s73, 110592
    buffer_load_dwordx4 v97, s[16:19], s66 offen lds
    s_add_u32 m0, s53, 53248
    s_add_u32 s66, s73, 147456
    buffer_load_dwordx4 v97, s[16:19], s66 offen lds
    s_add_u32 m0, s53, 57344
    s_add_u32 s66, s73, 184320
    buffer_load_dwordx4 v97, s[16:19], s66 offen lds
    s_add_u32 m0, s53, 61440
    s_add_u32 s66, s73, 221184
    buffer_load_dwordx4 v97, s[16:19], s66 offen lds
    s_add_u32 m0, s53, 65536
    s_add_u32 s66, s73, 258048
    buffer_load_dwordx4 v97, s[16:19], s66 offen lds
    s_add_u32 m0, s53, 69632
    s_add_u32 s66, s73, 294912
    buffer_load_dwordx4 v97, s[16:19], s66 offen lds
    s_waitcnt vmcnt(9)
    v_add_u32 v101, s83, v96
    buffer_load_dwordx4 v[64:67], v101, s[20:23], s44 offen
    v_lshl_add_u32 v32, v32, 6, v98
    v_lshl_add_u32 v40, v40, 6, v98
    v_lshl_add_u32 v48, v48, 6, v98
    v_lshl_add_u32 v56, v56, 6, v98
    buffer_load_dwordx4 v[68:71], v101, s[20:23], s45 offen
    v_lshl_add_u32 v33, v33, 6, v98
    v_lshl_add_u32 v41, v41, 6, v98
    v_lshl_add_u32 v49, v49, 6, v98
    v_lshl_add_u32 v57, v57, 6, v98
    buffer_load_dwordx4 v[72:75], v101, s[20:23], s46 offen
    v_lshl_add_u32 v32, v36, 10, v32
    v_lshl_add_u32 v40, v44, 10, v40
    v_lshl_add_u32 v48, v52, 10, v48
    v_lshl_add_u32 v56, v60, 10, v56
    buffer_load_dwordx4 v[76:79], v101, s[20:23], s47 offen
    v_lshl_add_u32 v33, v37, 10, v33
    v_lshl_add_u32 v41, v45, 10, v41
    v_lshl_add_u32 v49, v53, 10, v49
    v_lshl_add_u32 v57, v61, 10, v57
    buffer_load_dwordx4 v[80:83], v101, s[20:23], s48 offen
    v_lshl_add_u32 v34, v34, 6, v98
    v_lshl_add_u32 v42, v42, 6, v98
    v_lshl_add_u32 v50, v50, 6, v98
    v_lshl_add_u32 v58, v58, 6, v98
    buffer_load_dwordx4 v[84:87], v101, s[20:23], s49 offen
    v_lshl_add_u32 v35, v35, 6, v98
    v_lshl_add_u32 v43, v43, 6, v98
    v_lshl_add_u32 v51, v51, 6, v98
    v_lshl_add_u32 v59, v59, 6, v98
    buffer_load_dwordx4 v[88:91], v101, s[20:23], s50 offen
    v_lshl_add_u32 v34, v38, 10, v34
    v_lshl_add_u32 v42, v46, 10, v42
    v_lshl_add_u32 v50, v54, 10, v50
    v_lshl_add_u32 v58, v62, 10, v58
    buffer_load_dwordx4 v[92:95], v101, s[20:23], s51 offen
    v_lshl_add_u32 v35, v39, 10, v35
    v_lshl_add_u32 v43, v47, 10, v43
    v_lshl_add_u32 v51, v55, 10, v51
    v_lshl_add_u32 v59, v63, 10, v59
    s_add_u32 m0, s53, 73728
    s_add_u32 s66, s74, 0
    buffer_load_dwordx4 v97, s[16:19], s66 offen lds
    ds_read_b32 v36, v32
    ds_read_b32 v37, v40
    ds_read_b32 v38, v48
    ds_read_b32 v39, v56
    s_add_u32 m0, s53, 77824
    s_add_u32 s66, s74, 36864
    buffer_load_dwordx4 v97, s[16:19], s66 offen lds
    ds_read_b32 v44, v33
    ds_read_b32 v45, v41
    ds_read_b32 v46, v49
    ds_read_b32 v47, v57
    s_add_u32 m0, s53, 81920
    s_add_u32 s66, s74, 73728
    buffer_load_dwordx4 v97, s[16:19], s66 offen lds
    ds_read_b32 v52, v34
    ds_read_b32 v53, v42
    ds_read_b32 v54, v50
    ds_read_b32 v55, v58
    s_add_u32 m0, s53, 86016
    s_add_u32 s66, s74, 110592
    buffer_load_dwordx4 v97, s[16:19], s66 offen lds
    ds_read_b32 v60, v35
    ds_read_b32 v61, v43
    ds_read_b32 v62, v51
    ds_read_b32 v63, v59
    s_add_u32 m0, s53, 90112
    s_add_u32 s66, s74, 147456
    buffer_load_dwordx4 v97, s[16:19], s66 offen lds
    s_waitcnt lgkmcnt(12)
    ds_write_b128 v99, v[36:39] offset:16384
    s_waitcnt lgkmcnt(9)
    ds_write_b128 v99, v[44:47] offset:17408
    s_add_u32 m0, s53, 94208
    s_add_u32 s66, s74, 184320
    buffer_load_dwordx4 v97, s[16:19], s66 offen lds
    s_waitcnt lgkmcnt(6)
    ds_write_b128 v99, v[52:55] offset:18432
    s_waitcnt lgkmcnt(3)
    ds_write_b128 v99, v[60:63] offset:19456
    s_add_u32 m0, s53, 98304
    s_add_u32 s66, s74, 221184
    buffer_load_dwordx4 v97, s[16:19], s66 offen lds
    s_add_u32 m0, s53, 102400
    s_add_u32 s66, s74, 258048
    buffer_load_dwordx4 v97, s[16:19], s66 offen lds
    s_add_u32 m0, s53, 106496
    s_add_u32 s66, s74, 294912
    buffer_load_dwordx4 v97, s[16:19], s66 offen lds
    s_waitcnt vmcnt(17)
    s_waitcnt lgkmcnt(0)
    s_barrier
    s_cmp_eq_u32 s39, 1
    s_cbranch_scc0 L_sk3
    s_add_u32 m0, s41, 0
    s_add_u32 s66, s74, 331776
    buffer_load_dwordx4 v97, s[16:19], s66 offen lds
L_sk3:
    s_waitcnt vmcnt(9)
    v_add_u32 v101, s84, v96
    buffer_load_dwordx4 v[0:3], v101, s[20:23], s44 offen
    v_lshl_add_u32 v64, v64, 6, v98
    v_lshl_add_u32 v72, v72, 6, v98
    v_lshl_add_u32 v80, v80, 6, v98
    v_lshl_add_u32 v88, v88, 6, v98
    buffer_load_dwordx4 v[4:7], v101, s[20:23], s45 offen
    v_lshl_add_u32 v65, v65, 6, v98
    v_lshl_add_u32 v73, v73, 6, v98
    v_lshl_add_u32 v81, v81, 6, v98
    v_lshl_add_u32 v89, v89, 6, v98
    buffer_load_dwordx4 v[8:11], v101, s[20:23], s46 offen
    v_lshl_add_u32 v64, v68, 10, v64
    v_lshl_add_u32 v72, v76, 10, v72
    v_lshl_add_u32 v80, v84, 10, v80
    v_lshl_add_u32 v88, v92, 10, v88
    buffer_load_dwordx4 v[12:15], v101, s[20:23], s47 offen
    v_lshl_add_u32 v65, v69, 10, v65
    v_lshl_add_u32 v73, v77, 10, v73
    v_lshl_add_u32 v81, v85, 10, v81
    v_lshl_add_u32 v89, v93, 10, v89
    buffer_load_dwordx4 v[16:19], v101, s[20:23], s48 offen
    v_lshl_add_u32 v66, v66, 6, v98
    v_lshl_add_u32 v74, v74, 6, v98
    v_lshl_add_u32 v82, v82, 6, v98
    v_lshl_add_u32 v90, v90, 6, v98
    buffer_load_dwordx4 v[20:23], v101, s[20:23], s49 offen
    v_lshl_add_u32 v67, v67, 6, v98
    v_lshl_add_u32 v75, v75, 6, v98
    v_lshl_add_u32 v83, v83, 6, v98
    v_lshl_add_u32 v91, v91, 6, v98
    buffer_load_dwordx4 v[24:27], v101, s[20:23], s50 offen
    v_lshl_add_u32 v66, v70, 10, v66
    v_lshl_add_u32 v74, v78, 10, v74
    v_lshl_add_u32 v82, v86, 10, v82
    v_lshl_add_u32 v90, v94, 10, v90
    buffer_load_dwordx4 v[28:31], v101, s[20:23], s51 offen
    v_lshl_add_u32 v67, v71, 10, v67
    v_lshl_add_u32 v75, v79, 10, v75
    v_lshl_add_u32 v83, v87, 10, v83
    v_lshl_add_u32 v91, v95, 10, v91
    s_add_u32 m0, s53, 0
    s_add_u32 s66, s75, 0
    buffer_load_dwordx4 v97, s[16:19], s66 offen lds
    ds_read_b32 v68, v64
    ds_read_b32 v69, v72
    ds_read_b32 v70, v80
    ds_read_b32 v71, v88
    s_add_u32 m0, s53, 4096
    s_add_u32 s66, s75, 36864
    buffer_load_dwordx4 v97, s[16:19], s66 offen lds
    ds_read_b32 v76, v65
    ds_read_b32 v77, v73
    ds_read_b32 v78, v81
    ds_read_b32 v79, v89
    s_add_u32 m0, s53, 8192
    s_add_u32 s66, s75, 73728
    buffer_load_dwordx4 v97, s[16:19], s66 offen lds
    ds_read_b32 v84, v66
    ds_read_b32 v85, v74
    ds_read_b32 v86, v82
    ds_read_b32 v87, v90
    s_add_u32 m0, s53, 12288
    s_add_u32 s66, s75, 110592
    buffer_load_dwordx4 v97, s[16:19], s66 offen lds
    ds_read_b32 v92, v67
    ds_read_b32 v93, v75
    ds_read_b32 v94, v83
    ds_read_b32 v95, v91
    s_add_u32 m0, s53, 16384
    s_add_u32 s66, s75, 147456
    buffer_load_dwordx4 v97, s[16:19], s66 offen lds
    s_waitcnt lgkmcnt(12)
    ds_write_b128 v99, v[68:71] offset:0
    s_waitcnt lgkmcnt(9)
    ds_write_b128 v99, v[76:79] offset:1024
    s_add_u32 m0, s53, 20480
    s_add_u32 s66, s75, 184320
    buffer_load_dwordx4 v97, s[16:19], s66 offen lds
    s_waitcnt lgkmcnt(6)
    ds_write_b128 v99, v[84:87] offset:2048
    s_waitcnt lgkmcnt(3)
    ds_write_b128 v99, v[92:95] offset:3072
    s_add_u32 m0, s53, 24576
    s_add_u32 s66, s75, 221184
    buffer_load_dwordx4 v97, s[16:19], s66 offen lds
    s_add_u32 m0, s53, 28672
    s_add_u32 s66, s75, 258048
    buffer_load_dwordx4 v97, s[16:19], s66 offen lds
    s_add_u32 m0, s53, 32768
    s_add_u32 s66, s75, 294912
    buffer_load_dwordx4 v97, s[16:19], s66 offen lds
    v_add_u32 v101, s85, v96
    buffer_load_dwordx4 v[32:35], v101, s[20:23], s44 offen
    buffer_load_dwordx4 v[36:39], v101, s[20:23], s45 offen
    buffer_load_dwordx4 v[40:43], v101, s[20:23], s46 offen
    buffer_load_dwordx4 v[44:47], v101, s[20:23], s47 offen
    buffer_load_dwordx4 v[48:51], v101, s[20:23], s48 offen
    buffer_load_dwordx4 v[52:55], v101, s[20:23], s49 offen
    buffer_load_dwordx4 v[56:59], v101, s[20:23], s50 offen
    buffer_load_dwordx4 v[60:63], v101, s[20:23], s51 offen
    s_waitcnt vmcnt(25)
    s_waitcnt lgkmcnt(0)
    s_barrier
    s_waitcnt vmcnt(17)
    s_cmp_eq_u32 s39, 1
    s_cbranch_scc0 L_sk4
    s_add_u32 m0, s41, 2048
    s_add_u32 s66, s75, 331776
    buffer_load_dwordx4 v97, s[16:19], s66 offen lds
L_sk4:
    v_lshl_add_u32 v0, v0, 6, v98
    v_lshl_add_u32 v8, v8, 6, v98
    v_lshl_add_u32 v16, v16, 6, v98
    v_lshl_add_u32 v24, v24, 6, v98
    s_add_u32 m0, s53, 36864
    s_add_u32 s66, s76, 0
    buffer_load_dwordx4 v97, s[16:19], s66 offen lds
    v_lshl_add_u32 v1, v1, 6, v98
    v_lshl_add_u32 v9, v9, 6, v98
    v_lshl_add_u32 v17, v17, 6, v98
    v_lshl_add_u32 v25, v25, 6, v98
    s_add_u32 m0, s53, 40960
    s_add_u32 s66, s76, 36864
    buffer_load_dwordx4 v97, s[16:19], s66 offen lds
    v_lshl_add_u32 v0, v4, 10, v0
    v_lshl_add_u32 v8, v12, 10, v8
    v_lshl_add_u32 v16, v20, 10, v16
    v_lshl_add_u32 v24, v28, 10, v24
    s_add_u32 m0, s53, 45056
    s_add_u32 s66, s76, 73728
    buffer_load_dwordx4 v97, s[16:19], s66 offen lds
    v_lshl_add_u32 v1, v5, 10, v1
    v_lshl_add_u32 v9, v13, 10, v9
    v_lshl_add_u32 v17, v21, 10, v17
    v_lshl_add_u32 v25, v29, 10, v25
    s_add_u32 m0, s53, 49152
    s_add_u32 s66, s76, 110592
    buffer_load_dwordx4 v97, s[16:19], s66 offen lds
    v_lshl_add_u32 v2, v2, 6, v98
    v_lshl_add_u32 v10, v10, 6, v98
    v_lshl_add_u32 v18, v18, 6, v98
    v_lshl_add_u32 v26, v26, 6, v98
    s_add_u32 m0, s53, 53248
    s_add_u32 s66, s76, 147456
    buffer_load_dwordx4 v97, s[16:19], s66 offen lds
    v_lshl_add_u32 v3, v3, 6, v98
    v_lshl_add_u32 v11, v11, 6, v98
    v_lshl_add_u32 v19, v19, 6, v98
    v_lshl_add_u32 v27, v27, 6, v98
    s_add_u32 m0, s53, 57344
    s_add_u32 s66, s76, 184320
    buffer_load_dwordx4 v97, s[16:19], s66 offen lds
    v_lshl_add_u32 v2, v6, 10, v2
    v_lshl_add_u32 v10, v14, 10, v10
    v_lshl_add_u32 v18, v22, 10, v18
    v_lshl_add_u32 v26, v30, 10, v26
    s_add_u32 m0, s53, 61440
    s_add_u32 s66, s76, 221184
    buffer_load_dwordx4 v97, s[16:19], s66 offen lds
    v_lshl_add_u32 v3, v7, 10, v3
    v_lshl_add_u32 v11, v15, 10, v11
    v_lshl_add_u32 v19, v23, 10, v19
    v_lshl_add_u32 v27, v31, 10, v27
    s_add_u32 m0, s53, 65536
    s_add_u32 s66, s76, 258048
    buffer_load_dwordx4 v97, s[16:19], s66 offen lds
    ds_read_b32 v4, v0
    ds_read_b32 v5, v8
    ds_read_b32 v6, v16
    ds_read_b32 v7, v24
    s_add_u32 m0, s53, 69632
    s_add_u32 s66, s76, 294912
    buffer_load_dwordx4 v97, s[16:19], s66 offen lds
    ds_read_b32 v12, v1
    ds_read_b32 v13, v9
    ds_read_b32 v14, v17
    ds_read_b32 v15, v25
    v_add_u32 v101, s86, v96
    buffer_load_dwordx4 v[64:67], v101, s[20:23], s44 offen
    ds_read_b32 v20, v2
    ds_read_b32 v21, v10
    ds_read_b32 v22, v18
    ds_read_b32 v23, v26
    buffer_load_dwordx4 v[68:71], v101, s[20:23], s45 offen
    ds_read_b32 v28, v3
    ds_read_b32 v29, v11
    ds_read_b32 v30, v19
    ds_read_b32 v31, v27
    buffer_load_dwordx4 v[72:75], v101, s[20:23], s46 offen
    s_waitcnt lgkmcnt(12)
    ds_write_b128 v99, v[4:7] offset:16384
    s_waitcnt lgkmcnt(9)
    ds_write_b128 v99, v[12:15] offset:17408
    buffer_load_dwordx4 v[76:79], v101, s[20:23], s47 offen
    s_waitcnt lgkmcnt(6)
    ds_write_b128 v99, v[20:23] offset:18432
    s_waitcnt lgkmcnt(3)
    ds_write_b128 v99, v[28:31] offset:19456
    buffer_load_dwordx4 v[80:83], v101, s[20:23], s48 offen
    buffer_load_dwordx4 v[84:87], v101, s[20:23], s49 offen
    buffer_load_dwordx4 v[88:91], v101, s[20:23], s50 offen
    buffer_load_dwordx4 v[92:95], v101, s[20:23], s51 offen
    s_waitcnt vmcnt(17)
    s_waitcnt lgkmcnt(0)
    s_barrier
    s_cmp_eq_u32 s39, 1
    s_cbranch_scc0 L_sk5
    s_add_u32 m0, s41, 0
    s_add_u32 s66, s76, 331776
    buffer_load_dwordx4 v97, s[16:19], s66 offen lds
L_sk5:
    v_lshl_add_u32 v32, v32, 6, v98
    v_lshl_add_u32 v40, v40, 6, v98
    v_lshl_add_u32 v48, v48, 6, v98
    v_lshl_add_u32 v56, v56, 6, v98
    s_add_u32 m0, s53, 73728
    s_add_u32 s66, s77, 0
    buffer_load_dwordx4 v97, s[16:19], s66 offen lds
    v_lshl_add_u32 v33, v33, 6, v98
    v_lshl_add_u32 v41, v41, 6, v98
    v_lshl_add_u32 v49, v49, 6, v98
    v_lshl_add_u32 v57, v57, 6, v98
    s_add_u32 m0, s53, 77824
    s_add_u32 s66, s77, 36864
    buffer_load_dwordx4 v97, s[16:19], s66 offen lds
    v_lshl_add_u32 v32, v36, 10, v32
    v_lshl_add_u32 v40, v44, 10, v40
    v_lshl_add_u32 v48, v52, 10, v48
    v_lshl_add_u32 v56, v60, 10, v56
    s_add_u32 m0, s53, 81920
    s_add_u32 s66, s77, 73728
    buffer_load_dwordx4 v97, s[16:19], s66 offen lds
    v_lshl_add_u32 v33, v37, 10, v33
    v_lshl_add_u32 v41, v45, 10, v41
    v_lshl_add_u32 v49, v53, 10, v49
    v_lshl_add_u32 v57, v61, 10, v57
    s_add_u32 m0, s53, 86016
    s_add_u32 s66, s77, 110592
    buffer_load_dwordx4 v97, s[16:19], s66 offen lds
    v_lshl_add_u32 v34, v34, 6, v98
    v_lshl_add_u32 v42, v42, 6, v98
    v_lshl_add_u32 v50, v50, 6, v98
    v_lshl_add_u32 v58, v58, 6, v98
    s_add_u32 m0, s53, 90112
    s_add_u32 s66, s77, 147456
    buffer_load_dwordx4 v97, s[16:19], s66 offen lds
    v_lshl_add_u32 v35, v35, 6, v98
    v_lshl_add_u32 v43, v43, 6, v98
    v_lshl_add_u32 v51, v51, 6, v98
    v_lshl_add_u32 v59, v59, 6, v98
    s_add_u32 m0, s53, 94208
    s_add_u32 s66, s77, 184320
    buffer_load_dwordx4 v97, s[16:19], s66 offen lds
    v_lshl_add_u32 v34, v38, 10, v34
    v_lshl_add_u32 v42, v46, 10, v42
    v_lshl_add_u32 v50, v54, 10, v50
    v_lshl_add_u32 v58, v62, 10, v58
    s_add_u32 m0, s53, 98304
    s_add_u32 s66, s77, 221184
    buffer_load_dwordx4 v97, s[16:19], s66 offen lds
    v_lshl_add_u32 v35, v39, 10, v35
    v_lshl_add_u32 v43, v47, 10, v43
    v_lshl_add_u32 v51, v55, 10, v51
    v_lshl_add_u32 v59, v63, 10, v59
    s_add_u32 m0, s53, 102400
    s_add_u32 s66, s77, 258048
    buffer_load_dwordx4 v97, s[16:19], s66 offen lds
    ds_read_b32 v36, v32
    ds_read_b32 v37, v40
    ds_read_b32 v38, v48
    ds_read_b32 v39, v56
    s_add_u32 m0, s53, 106496
    s_add_u32 s66, s77, 294912
    buffer_load_dwordx4 v97, s[16:19], s66 offen lds
    ds_read_b32 v44, v33
    ds_read_b32 v45, v41
    ds_read_b32 v46, v49
    ds_read_b32 v47, v57
    v_add_u32 v101, s87, v96
    buffer_load_dwordx4 v[0:3], v101, s[20:23], s44 offen
    ds_read_b32 v52, v34
    ds_read_b32 v53, v42
    ds_read_b32 v54, v50
    ds_read_b32 v55, v58
    buffer_load_dwordx4 v[4:7], v101, s[20:23], s45 offen
    ds_read_b32 v60, v35
    ds_read_b32 v61, v43
    ds_read_b32 v62, v51
    ds_read_b32 v63, v59
    buffer_load_dwordx4 v[8:11], v101, s[20:23], s46 offen
    s_waitcnt lgkmcnt(12)
    ds_write_b128 v99, v[36:39] offset:0
    s_waitcnt lgkmcnt(9)
    ds_write_b128 v99, v[44:47] offset:1024
    buffer_load_dwordx4 v[12:15], v101, s[20:23], s47 offen
    s_waitcnt lgkmcnt(6)
    ds_write_b128 v99, v[52:55] offset:2048
    s_waitcnt lgkmcnt(3)
    ds_write_b128 v99, v[60:63] offset:3072
    buffer_load_dwordx4 v[16:19], v101, s[20:23], s48 offen
    buffer_load_dwordx4 v[20:23], v101, s[20:23], s49 offen
    buffer_load_dwordx4 v[24:27], v101, s[20:23], s50 offen
    buffer_load_dwordx4 v[28:31], v101, s[20:23], s51 offen
    s_waitcnt vmcnt(17)
    s_waitcnt lgkmcnt(0)
    s_barrier
    s_cmp_eq_u32 s39, 1
    s_cbranch_scc0 L_sk6
    s_add_u32 m0, s41, 2048
    s_add_u32 s66, s77, 331776
    buffer_load_dwordx4 v97, s[16:19], s66 offen lds
L_sk6:
    v_lshl_add_u32 v64, v64, 6, v98
    v_lshl_add_u32 v72, v72, 6, v98
    v_lshl_add_u32 v80, v80, 6, v98
    v_lshl_add_u32 v88, v88, 6, v98
    s_add_u32 m0, s53, 0
    s_add_u32 s66, s78, 0
    buffer_load_dwordx4 v97, s[16:19], s66 offen lds
    v_lshl_add_u32 v65, v65, 6, v98
    v_lshl_add_u32 v73, v73, 6, v98
    v_lshl_add_u32 v81, v81, 6, v98
    v_lshl_add_u32 v89, v89, 6, v98
    s_add_u32 m0, s53, 4096
    s_add_u32 s66, s78, 36864
    buffer_load_dwordx4 v97, s[16:19], s66 offen lds
    v_lshl_add_u32 v64, v68, 10, v64
    v_lshl_add_u32 v72, v76, 10, v72
    v_lshl_add_u32 v80, v84, 10, v80
    v_lshl_add_u32 v88, v92, 10, v88
    s_add_u32 m0, s53, 8192
    s_add_u32 s66, s78, 73728
    buffer_load_dwordx4 v97, s[16:19], s66 offen lds
    v_lshl_add_u32 v65, v69, 10, v65
    v_lshl_add_u32 v73, v77, 10, v73
    v_lshl_add_u32 v81, v85, 10, v81
    v_lshl_add_u32 v89, v93, 10, v89
    s_add_u32 m0, s53, 12288
    s_add_u32 s66, s78, 110592
    buffer_load_dwordx4 v97, s[16:19], s66 offen lds
    v_lshl_add_u32 v66, v66, 6, v98
    v_lshl_add_u32 v74, v74, 6, v98
    v_lshl_add_u32 v82, v82, 6, v98
    v_lshl_add_u32 v90, v90, 6, v98
    s_add_u32 m0, s53, 16384
    s_add_u32 s66, s78, 147456
    buffer_load_dwordx4 v97, s[16:19], s66 offen lds
    v_lshl_add_u32 v67, v67, 6, v98
    v_lshl_add_u32 v75, v75, 6, v98
    v_lshl_add_u32 v83, v83, 6, v98
    v_lshl_add_u32 v91, v91, 6, v98
    s_add_u32 m0, s53, 20480
    s_add_u32 s66, s78, 184320
    buffer_load_dwordx4 v97, s[16:19], s66 offen lds
    v_lshl_add_u32 v66, v70, 10, v66
    v_lshl_add_u32 v74, v78, 10, v74
    v_lshl_add_u32 v82, v86, 10, v82
    v_lshl_add_u32 v90, v94, 10, v90
    s_add_u32 m0, s53, 24576
    s_add_u32 s66, s78, 221184
    buffer_load_dwordx4 v97, s[16:19], s66 offen lds
    v_lshl_add_u32 v67, v71, 10, v67
    v_lshl_add_u32 v75, v79, 10, v75
    v_lshl_add_u32 v83, v87, 10, v83
    v_lshl_add_u32 v91, v95, 10, v91
    s_add_u32 m0, s53, 28672
    s_add_u32 s66, s78, 258048
    buffer_load_dwordx4 v97, s[16:19], s66 offen lds
    ds_read_b32 v68, v64
    ds_read_b32 v69, v72
    ds_read_b32 v70, v80
    ds_read_b32 v71, v88
    s_add_u32 m0, s53, 32768
    s_add_u32 s66, s78, 294912
    buffer_load_dwordx4 v97, s[16:19], s66 offen lds
    ds_read_b32 v76, v65
    ds_read_b32 v77, v73
    ds_read_b32 v78, v81
    ds_read_b32 v79, v89
    v_add_u32 v101, s88, v96
    buffer_load_dwordx4 v[32:35], v101, s[20:23], s44 offen
    ds_read_b32 v84, v66
    ds_read_b32 v85, v74
    ds_read_b32 v86, v82
    ds_read_b32 v87, v90
    buffer_load_dwordx4 v[36:39], v101, s[20:23], s45 offen
    ds_read_b32 v92, v67
    ds_read_b32 v93, v75
    ds_read_b32 v94, v83
    ds_read_b32 v95, v91
    buffer_load_dwordx4 v[40:43], v101, s[20:23], s46 offen
    s_waitcnt lgkmcnt(12)
    ds_write_b128 v99, v[68:71] offset:16384
    s_waitcnt lgkmcnt(9)
    ds_write_b128 v99, v[76:79] offset:17408
    buffer_load_dwordx4 v[44:47], v101, s[20:23], s47 offen
    s_waitcnt lgkmcnt(6)
    ds_write_b128 v99, v[84:87] offset:18432
    s_waitcnt lgkmcnt(3)
    ds_write_b128 v99, v[92:95] offset:19456
    buffer_load_dwordx4 v[48:51], v101, s[20:23], s48 offen
    buffer_load_dwordx4 v[52:55], v101, s[20:23], s49 offen
    buffer_load_dwordx4 v[56:59], v101, s[20:23], s50 offen
    buffer_load_dwordx4 v[60:63], v101, s[20:23], s51 offen
    s_waitcnt vmcnt(17)
    s_waitcnt lgkmcnt(0)
    s_barrier
    s_cmp_eq_u32 s39, 1
    s_cbranch_scc0 L_sk7
    s_add_u32 m0, s41, 0
    s_add_u32 s66, s78, 331776
    buffer_load_dwordx4 v97, s[16:19], s66 offen lds
L_sk7:
    v_lshl_add_u32 v0, v0, 6, v98
    v_lshl_add_u32 v8, v8, 6, v98
    v_lshl_add_u32 v16, v16, 6, v98
    v_lshl_add_u32 v24, v24, 6, v98
    s_add_u32 m0, s53, 36864
    s_add_u32 s66, s79, 0
    buffer_load_dwordx4 v97, s[16:19], s66 offen lds
    v_lshl_add_u32 v1, v1, 6, v98
    v_lshl_add_u32 v9, v9, 6, v98
    v_lshl_add_u32 v17, v17, 6, v98
    v_lshl_add_u32 v25, v25, 6, v98
    s_add_u32 m0, s53, 40960
    s_add_u32 s66, s79, 36864
    buffer_load_dwordx4 v97, s[16:19], s66 offen lds
    v_lshl_add_u32 v0, v4, 10, v0
    v_lshl_add_u32 v8, v12, 10, v8
    v_lshl_add_u32 v16, v20, 10, v16
    v_lshl_add_u32 v24, v28, 10, v24
    s_add_u32 m0, s53, 45056
    s_add_u32 s66, s79, 73728
    buffer_load_dwordx4 v97, s[16:19], s66 offen lds
    v_lshl_add_u32 v1, v5, 10, v1
    v_lshl_add_u32 v9, v13, 10, v9
    v_lshl_add_u32 v17, v21, 10, v17
    v_lshl_add_u32 v25, v29, 10, v25
    s_add_u32 m0, s53, 49152
    s_add_u32 s66, s79, 110592
    buffer_load_dwordx4 v97, s[16:19], s66 offen lds
    v_lshl_add_u32 v2, v2, 6, v98
    v_lshl_add_u32 v10, v10, 6, v98
    v_lshl_add_u32 v18, v18, 6, v98
    v_lshl_add_u32 v26, v26, 6, v98
    s_add_u32 m0, s53, 53248
    s_add_u32 s66, s79, 147456
    buffer_load_dwordx4 v97, s[16:19], s66 offen lds
    v_lshl_add_u32 v3, v3, 6, v98
    v_lshl_add_u32 v11, v11, 6, v98
    v_lshl_add_u32 v19, v19, 6, v98
    v_lshl_add_u32 v27, v27, 6, v98
    s_add_u32 m0, s53, 57344
    s_add_u32 s66, s79, 184320
    buffer_load_dwordx4 v97, s[16:19], s66 offen lds
    v_lshl_add_u32 v2, v6, 10, v2
    v_lshl_add_u32 v10, v14, 10, v10
    v_lshl_add_u32 v18, v22, 10, v18
    v_lshl_add_u32 v26, v30, 10, v26
    s_add_u32 m0, s53, 61440
    s_add_u32 s66, s79, 221184
    buffer_load_dwordx4 v97, s[16:19], s66 offen lds
    v_lshl_add_u32 v3, v7, 10, v3
    v_lshl_add_u32 v11, v15, 10, v11
    v_lshl_add_u32 v19, v23, 10, v19
    v_lshl_add_u32 v27, v31, 10, v27
    s_add_u32 m0, s53, 65536
    s_add_u32 s66, s79, 258048
    buffer_load_dwordx4 v97, s[16:19], s66 offen lds
    ds_read_b32 v4, v0
    ds_read_b32 v5, v8
    ds_read_b32 v6, v16
    ds_read_b32 v7, v24
    s_add_u32 m0, s53, 69632
    s_add_u32 s66, s79, 294912
    buffer_load_dwordx4 v97, s[16:19], s66 offen lds
    ds_read_b32 v12, v1
    ds_read_b32 v13, v9
    ds_read_b32 v14, v17
    ds_read_b32 v15, v25
    v_add_u32 v101, s89, v96
    buffer_load_dwordx4 v[64:67], v101, s[20:23], s44 offen
    ds_read_b32 v20, v2
    ds_read_b32 v21, v10
    ds_read_b32 v22, v18
    ds_read_b32 v23, v26
    buffer_load_dwordx4 v[68:71], v101, s[20:23], s45 offen
    ds_read_b32 v28, v3
    ds_read_b32 v29, v11
    ds_read_b32 v30, v19
    ds_read_b32 v31, v27
    buffer_load_dwordx4 v[72:75], v101, s[20:23], s46 offen
    s_waitcnt lgkmcnt(12)
    ds_write_b128 v99, v[4:7] offset:0
    s_waitcnt lgkmcnt(9)
    ds_write_b128 v99, v[12:15] offset:1024
    buffer_load_dwordx4 v[76:79], v101, s[20:23], s47 offen
    s_waitcnt lgkmcnt(6)
    ds_write_b128 v99, v[20:23] offset:2048
    s_waitcnt lgkmcnt(3)
    ds_write_b128 v99, v[28:31] offset:3072
    buffer_load_dwordx4 v[80:83], v101, s[20:23], s48 offen
    buffer_load_dwordx4 v[84:87], v101, s[20:23], s49 offen
    buffer_load_dwordx4 v[88:91], v101, s[20:23], s50 offen
    buffer_load_dwordx4 v[92:95], v101, s[20:23], s51 offen
    s_waitcnt vmcnt(17)
    s_waitcnt lgkmcnt(0)
    s_barrier
    s_cmp_eq_u32 s39, 1
    s_cbranch_scc0 L_sk8
    s_add_u32 m0, s41, 2048
    s_add_u32 s66, s79, 331776
    buffer_load_dwordx4 v97, s[16:19], s66 offen lds
L_sk8:
    v_lshl_add_u32 v32, v32, 6, v98
    v_lshl_add_u32 v40, v40, 6, v98
    v_lshl_add_u32 v48, v48, 6, v98
    v_lshl_add_u32 v56, v56, 6, v98
    v_lshl_add_u32 v33, v33, 6, v98
    v_lshl_add_u32 v41, v41, 6, v98
    s_add_u32 m0, s53, 73728
    s_add_u32 s66, s80, 0
    buffer_load_dwordx4 v97, s[16:19], s66 offen lds
    v_lshl_add_u32 v49, v49, 6, v98
    v_lshl_add_u32 v57, v57, 6, v98
    v_lshl_add_u32 v32, v36, 10, v32
    v_lshl_add_u32 v40, v44, 10, v40
    v_lshl_add_u32 v48, v52, 10, v48
    v_lshl_add_u32 v56, v60, 10, v56
    s_add_u32 m0, s53, 77824
    s_add_u32 s66, s80, 36864
    buffer_load_dwordx4 v97, s[16:19], s66 offen lds
    v_lshl_add_u32 v33, v37, 10, v33
    v_lshl_add_u32 v41, v45, 10, v41
    v_lshl_add_u32 v49, v53, 10, v49
    v_lshl_add_u32 v57, v61, 10, v57
    v_lshl_add_u32 v34, v34, 6, v98
    v_lshl_add_u32 v42, v42, 6, v98
    s_add_u32 m0, s53, 81920
    s_add_u32 s66, s80, 73728
    buffer_load_dwordx4 v97, s[16:19], s66 offen lds
    v_lshl_add_u32 v50, v50, 6, v98
    v_lshl_add_u32 v58, v58, 6, v98
    v_lshl_add_u32 v35, v35, 6, v98
    v_lshl_add_u32 v43, v43, 6, v98
    v_lshl_add_u32 v51, v51, 6, v98
    v_lshl_add_u32 v59, v59, 6, v98
    s_add_u32 m0, s53, 86016
    s_add_u32 s66, s80, 110592
    buffer_load_dwordx4 v97, s[16:19], s66 offen lds
    v_lshl_add_u32 v34, v38, 10, v34
    v_lshl_add_u32 v42, v46, 10, v42
    v_lshl_add_u32 v50, v54, 10, v50
    v_lshl_add_u32 v58, v62, 10, v58
    v_lshl_add_u32 v35, v39, 10, v35
    v_lshl_add_u32 v43, v47, 10, v43
    s_add_u32 m0, s53, 90112
    s_add_u32 s66, s80, 147456
    buffer_load_dwordx4 v97, s[16:19], s66 offen lds
    v_lshl_add_u32 v51, v55, 10, v51
    v_lshl_add_u32 v59, v63, 10, v59
    ds_read_b32 v36, v32
    ds_read_b32 v37, v40
    ds_read_b32 v38, v48
    ds_read_b32 v39, v56
    s_add_u32 m0, s53, 94208
    s_add_u32 s66, s80, 184320
    buffer_load_dwordx4 v97, s[16:19], s66 offen lds
    ds_read_b32 v44, v33
    ds_read_b32 v45, v41
    ds_read_b32 v46, v49
    ds_read_b32 v47, v57
    ds_read_b32 v52, v34
    ds_read_b32 v53, v42
    s_add_u32 m0, s53, 98304
    s_add_u32 s66, s80, 221184
    buffer_load_dwordx4 v97, s[16:19], s66 offen lds
    ds_read_b32 v54, v50
    ds_read_b32 v55, v58
    ds_read_b32 v60, v35
    ds_read_b32 v61, v43
    ds_read_b32 v62, v51
    ds_read_b32 v63, v59
    s_add_u32 m0, s53, 102400
    s_add_u32 s66, s80, 258048
    buffer_load_dwordx4 v97, s[16:19], s66 offen lds
    s_waitcnt lgkmcnt(12)
    ds_write_b128 v99, v[36:39] offset:16384
    s_waitcnt lgkmcnt(9)
    ds_write_b128 v99, v[44:47] offset:17408
    s_waitcnt lgkmcnt(6)
    ds_write_b128 v99, v[52:55] offset:18432
    s_add_u32 m0, s53, 106496
    s_add_u32 s66, s80, 294912
    buffer_load_dwordx4 v97, s[16:19], s66 offen lds
    s_waitcnt lgkmcnt(3)
    ds_write_b128 v99, v[60:63] offset:19456
    s_waitcnt vmcnt(9)
    s_waitcnt lgkmcnt(0)
    s_barrier
    s_cmp_eq_u32 s39, 1
    s_cbranch_scc0 L_sk9
    s_add_u32 m0, s41, 0
    s_add_u32 s66, s80, 331776
    buffer_load_dwordx4 v97, s[16:19], s66 offen lds
L_sk9:
    v_lshl_add_u32 v64, v64, 6, v98
    v_lshl_add_u32 v72, v72, 6, v98
    v_lshl_add_u32 v80, v80, 6, v98
    v_lshl_add_u32 v88, v88, 6, v98
    v_lshl_add_u32 v65, v65, 6, v98
    v_lshl_add_u32 v73, v73, 6, v98
    v_lshl_add_u32 v81, v81, 6, v98
    v_lshl_add_u32 v89, v89, 6, v98
    v_lshl_add_u32 v64, v68, 10, v64
    v_lshl_add_u32 v72, v76, 10, v72
    v_lshl_add_u32 v80, v84, 10, v80
    v_lshl_add_u32 v88, v92, 10, v88
    v_lshl_add_u32 v65, v69, 10, v65
    v_lshl_add_u32 v73, v77, 10, v73
    v_lshl_add_u32 v81, v85, 10, v81
    v_lshl_add_u32 v89, v93, 10, v89
    v_lshl_add_u32 v66, v66, 6, v98
    v_lshl_add_u32 v74, v74, 6, v98
    v_lshl_add_u32 v82, v82, 6, v98
    v_lshl_add_u32 v90, v90, 6, v98
    v_lshl_add_u32 v67, v67, 6, v98
    v_lshl_add_u32 v75, v75, 6, v98
    v_lshl_add_u32 v83, v83, 6, v98
    v_lshl_add_u32 v91, v91, 6, v98
    v_lshl_add_u32 v66, v70, 10, v66
    v_lshl_add_u32 v74, v78, 10, v74
    v_lshl_add_u32 v82, v86, 10, v82
    v_lshl_add_u32 v90, v94, 10, v90
    v_lshl_add_u32 v67, v71, 10, v67
    v_lshl_add_u32 v75, v79, 10, v75
    v_lshl_add_u32 v83, v87, 10, v83
    v_lshl_add_u32 v91, v95, 10, v91
    ds_read_b32 v68, v64
    ds_read_b32 v69, v72
    ds_read_b32 v70, v80
    ds_read_b32 v71, v88
    ds_read_b32 v76, v65
    ds_read_b32 v77, v73
    ds_read_b32 v78, v81
    ds_read_b32 v79, v89
    ds_read_b32 v84, v66
    ds_read_b32 v85, v74
    ds_read_b32 v86, v82
    ds_read_b32 v87, v90
    ds_read_b32 v92, v67
    ds_read_b32 v93, v75
    ds_read_b32 v94, v83
    ds_read_b32 v95, v91
    s_waitcnt lgkmcnt(12)
    ds_write_b128 v99, v[68:71] offset:0
    s_waitcnt lgkmcnt(9)
    ds_write_b128 v99, v[76:79] offset:1024
    s_waitcnt lgkmcnt(6)
    ds_write_b128 v99, v[84:87] offset:2048
    s_waitcnt lgkmcnt(3)
    ds_write_b128 v99, v[92:95] offset:3072
    s_waitcnt vmcnt(0)
    s_waitcnt lgkmcnt(0)
    s_barrier
    s_endpgm
L_consumer:
    v_mov_b32 v236, v0
    s_and_b32 s56, s40, 1
    s_lshr_b32 s57, s40, 1
    s_cmp_eq_u32 s57, 1
    s_cselect_b64 s[58:59], -1, 0
    v_and_b32 v5, 15, v236
    v_lshrrev_b32 v7, 4, v236
    v_lshrrev_b32 v6, 1, v5
    v_xor_b32 v6, v6, v7
    v_lshlrev_b32 v6, 4, v6
    v_lshl_add_u32 v6, v5, 7, v6
    v_add_u32 v228, 110592, v6
    v_xor_b32 v229, 64, v228
    s_mul_i32 s43, s57, 18432
    v_add_u32 v226, s43, v6
    v_xor_b32 v227, 64, v226
    s_lshl_b32 s43, s56, 12
    s_add_u32 s43, s43, 114688
    s_lshl_b32 s54, s57, 11
    s_add_u32 s55, s43, s54
    v_lshlrev_b32 v6, 4, v236
    v_add_u32 v230, s55, v6
    v_xor_b32 v231, 2048, v230
    v_mul_u32_u24 v232, 36864, v7
    v_lshl_add_u32 v232, v5, 3, v232
    v_add_u32 v233, 9216, v232
    v_add_u32 v234, 18432, v232
    v_add_u32 v235, 27648, v232
    s_lshl_b32 s43, s40, 12
    s_add_u32 s43, s43, 147456
    v_lshlrev_b32 v6, 4, v236
    v_add_u32 v6, s43, v6
    v_lshrrev_b32 v1, 2, v236
    v_lshlrev_b32 v1, 1, v1
    v_lshlrev_b32 v4, 3, v5
    s_waitcnt lgkmcnt(0)
    s_mov_b32 s28, s8
    s_and_b32 s29, s9, 0xffff
    s_mov_b32 s30, 32
    s_mov_b32 s31, 0x20000
    buffer_load_ushort v2, v1, s[28:31], 0 offen
    s_lshl_b32 s42, s40, 3
    s_add_u32 s8, s8, s42
    s_addc_u32 s9, s9, 0
    s_load_dwordx2 s[54:55], s[8:9], 0
    s_mov_b32 s32, s10
    s_and_b32 s33, s11, 0xffff
    s_mov_b32 s34, 9216
    s_mov_b32 s35, 0x20000
    s_mov_b32 s24, s12
    s_and_b32 s25, s13, 0xffff
    s_mov_b32 s26, 18874368
    s_mov_b32 s27, 0x20000
    s_lshl_b32 s42, s36, 8
    s_lshl_b32 s43, s56, 7
    s_add_u32 s42, s42, s43
    buffer_load_dwordx2 v[8:9], v4, s[32:35], s42 offen
    s_mul_i32 s41, s57, 9
    s_add_u32 s41, s41, s38
    s_mul_i32 s41, s41, 147456
    s_add_u32 s41, s41, s42
    s_add_u32 s67, s38, 18
    s_mul_i32 s67, s67, 147456
    s_add_u32 s67, s67, s42
    s_lshl_b32 s43, s57, 2
    s_add_u32 s67, s67, s43
    s_waitcnt vmcnt(1) lgkmcnt(0)
    s_lshl_b32 s68, s54, 16
    s_and_b32 s69, s54, 0xffff0000
    s_lshl_b32 s70, s55, 16
    s_and_b32 s71, s55, 0xffff0000
    v_or_b32 v16, s68, v2
    v_or_b32 v17, s68, v2
    v_or_b32 v18, s68, v2
    v_or_b32 v19, s68, v2
    ds_write_b128 v6, v[16:19] offset:0
    v_or_b32 v20, s69, v2
    v_or_b32 v21, s69, v2
    v_or_b32 v22, s69, v2
    v_or_b32 v23, s69, v2
    ds_write_b128 v6, v[20:23] offset:1024
    v_or_b32 v24, s70, v2
    v_or_b32 v25, s70, v2
    v_or_b32 v26, s70, v2
    v_or_b32 v27, s70, v2
    ds_write_b128 v6, v[24:27] offset:2048
    v_or_b32 v28, s71, v2
    v_or_b32 v29, s71, v2
    v_or_b32 v30, s71, v2
    v_or_b32 v31, s71, v2
    ds_write_b128 v6, v[28:31] offset:3072
    s_waitcnt vmcnt(0)
    s_mov_b64 exec, s[58:59]
    v_swap_b32 v8, v9
    s_mov_b64 exec, -1
    v_lshlrev_b32 v204, 16, v8
    v_and_b32 v205, 0xffff0000, v8
    v_lshlrev_b32 v206, 16, v9
    v_and_b32 v207, 0xffff0000, v9
    s_waitcnt lgkmcnt(0)
    s_barrier
    s_mov_b32 s72, 16384
    s_mov_b32 s73, 2048
    s_mov_b32 s74, 0
    s_mov_b32 s75, 8
    v_mov_b64 v[0:1], 0
    v_mov_b64 v[2:3], 0
    v_mov_b64 v[4:5], 0
    v_mov_b64 v[6:7], 0
    v_mov_b64 v[8:9], 0
    v_mov_b64 v[10:11], 0
    v_mov_b64 v[12:13], 0
    v_mov_b64 v[14:15], 0
    v_mov_b64 v[16:17], 0
    v_mov_b64 v[18:19], 0
    v_mov_b64 v[20:21], 0
    v_mov_b64 v[22:23], 0
    v_mov_b64 v[24:25], 0
    v_mov_b64 v[26:27], 0
    v_mov_b64 v[28:29], 0
    v_mov_b64 v[30:31], 0
    v_mov_b64 v[32:33], 0
    v_mov_b64 v[34:35], 0
    v_mov_b64 v[36:37], 0
    v_mov_b64 v[38:39], 0
    v_mov_b64 v[40:41], 0
    v_mov_b64 v[42:43], 0
    v_mov_b64 v[44:45], 0
    v_mov_b64 v[46:47], 0
    v_mov_b64 v[48:49], 0
    v_mov_b64 v[50:51], 0
    v_mov_b64 v[52:53], 0
    v_mov_b64 v[54:55], 0
    v_mov_b64 v[56:57], 0
    v_mov_b64 v[58:59], 0
    v_mov_b64 v[60:61], 0
    v_mov_b64 v[62:63], 0
    v_mov_b64 v[64:65], 0
    v_mov_b64 v[66:67], 0
    v_mov_b64 v[68:69], 0
    v_mov_b64 v[70:71], 0
    v_mov_b64 v[72:73], 0
    v_mov_b64 v[74:75], 0
    v_mov_b64 v[76:77], 0
    v_mov_b64 v[78:79], 0
    v_mov_b64 v[80:81], 0
    v_mov_b64 v[82:83], 0
    v_mov_b64 v[84:85], 0
    v_mov_b64 v[86:87], 0
    v_mov_b64 v[88:89], 0
    v_mov_b64 v[90:91], 0
    v_mov_b64 v[92:93], 0
    v_mov_b64 v[94:95], 0
    v_mov_b64 v[96:97], 0
    v_mov_b64 v[98:99], 0
    v_mov_b64 v[100:101], 0
    v_mov_b64 v[102:103], 0
    v_mov_b64 v[104:105], 0
    v_mov_b64 v[106:107], 0
    v_mov_b64 v[108:109], 0
    v_mov_b64 v[110:111], 0
    v_mov_b64 v[112:113], 0
    v_mov_b64 v[114:115], 0
    v_mov_b64 v[116:117], 0
    v_mov_b64 v[118:119], 0
    v_mov_b64 v[120:121], 0
    v_mov_b64 v[122:123], 0
    v_mov_b64 v[124:125], 0
    v_mov_b64 v[126:127], 0
    v_mov_b64 v[128:129], 0
    v_mov_b64 v[130:131], 0
    v_mov_b64 v[132:133], 0
    v_mov_b64 v[134:135], 0
    v_mov_b64 v[136:137], 0
    v_mov_b64 v[138:139], 0
    v_mov_b64 v[140:141], 0
    v_mov_b64 v[142:143], 0
    v_mov_b64 v[144:145], 0
    v_mov_b64 v[146:147], 0
    v_mov_b64 v[148:149], 0
    v_mov_b64 v[150:151], 0
    s_barrier
    ds_read_b128 v[152:155], v230 offset:0
    ds_read_b128 v[156:159], v230 offset:1024
    ds_read_b128 v[160:163], v231 offset:0
    ds_read_b128 v[164:167], v231 offset:1024
    v_add_u32 v237, s74, v226
    v_add_u32 v238, s74, v227
    ds_read_b128 v[184:187], v237 offset:0
    ds_read_b128 v[188:191], v237 offset:2048
    ds_read_b128 v[192:195], v237 offset:4096
L_cloop:
    ds_read_b128 v[196:199], v237 offset:6144
    ds_read_b128 v[168:171], v230 offset:8192
    ds_read_b128 v[172:175], v230 offset:9216
    ds_read_b128 v[176:179], v231 offset:8192
    ds_read_b128 v[180:183], v231 offset:9216
    s_waitcnt lgkmcnt(7)
    v_mfma_f32_16x16x32_bf16 v[0:3], v[184:187], v[152:155], v[0:3]
    v_mfma_f32_16x16x32_bf16 v[4:7], v[184:187], v[156:159], v[4:7]
    v_mfma_f32_16x16x32_bf16 v[8:11], v[184:187], v[160:163], v[8:11]
    v_mfma_f32_16x16x32_bf16 v[12:15], v[184:187], v[164:167], v[12:15]
    ds_read_b128 v[200:203], v237 offset:8192
    s_waitcnt lgkmcnt(7)
    v_mfma_f32_16x16x32_bf16 v[16:19], v[188:191], v[152:155], v[16:19]
    v_mfma_f32_16x16x32_bf16 v[20:23], v[188:191], v[156:159], v[20:23]
    v_mfma_f32_16x16x32_bf16 v[24:27], v[188:191], v[160:163], v[24:27]
    v_mfma_f32_16x16x32_bf16 v[28:31], v[188:191], v[164:167], v[28:31]
    ds_read_b128 v[184:187], v237 offset:10240
    s_waitcnt lgkmcnt(7)
    v_mfma_f32_16x16x32_bf16 v[32:35], v[192:195], v[152:155], v[32:35]
    v_mfma_f32_16x16x32_bf16 v[36:39], v[192:195], v[156:159], v[36:39]
    v_mfma_f32_16x16x32_bf16 v[40:43], v[192:195], v[160:163], v[40:43]
    v_mfma_f32_16x16x32_bf16 v[44:47], v[192:195], v[164:167], v[44:47]
    ds_read_b128 v[188:191], v237 offset:12288
    s_waitcnt lgkmcnt(7)
    v_mfma_f32_16x16x32_bf16 v[48:51], v[196:199], v[152:155], v[48:51]
    v_mfma_f32_16x16x32_bf16 v[52:55], v[196:199], v[156:159], v[52:55]
    v_mfma_f32_16x16x32_bf16 v[56:59], v[196:199], v[160:163], v[56:59]
    v_mfma_f32_16x16x32_bf16 v[60:63], v[196:199], v[164:167], v[60:63]
    ds_read_b128 v[192:195], v237 offset:14336
    s_waitcnt lgkmcnt(3)
    v_mfma_f32_16x16x32_bf16 v[64:67], v[200:203], v[152:155], v[64:67]
    v_mfma_f32_16x16x32_bf16 v[68:71], v[200:203], v[156:159], v[68:71]
    v_mfma_f32_16x16x32_bf16 v[72:75], v[200:203], v[160:163], v[72:75]
    v_mfma_f32_16x16x32_bf16 v[76:79], v[200:203], v[164:167], v[76:79]
    ds_read_b128 v[196:199], v237 offset:16384
    s_waitcnt lgkmcnt(3)
    v_mfma_f32_16x16x32_bf16 v[80:83], v[184:187], v[152:155], v[80:83]
    v_mfma_f32_16x16x32_bf16 v[84:87], v[184:187], v[156:159], v[84:87]
    v_mfma_f32_16x16x32_bf16 v[88:91], v[184:187], v[160:163], v[88:91]
    v_mfma_f32_16x16x32_bf16 v[92:95], v[184:187], v[164:167], v[92:95]
    ds_read_b128 v[200:203], v228 offset:0
    s_waitcnt lgkmcnt(3)
    v_mfma_f32_16x16x32_bf16 v[96:99], v[188:191], v[152:155], v[96:99]
    v_mfma_f32_16x16x32_bf16 v[100:103], v[188:191], v[156:159], v[100:103]
    v_mfma_f32_16x16x32_bf16 v[104:107], v[188:191], v[160:163], v[104:107]
    v_mfma_f32_16x16x32_bf16 v[108:111], v[188:191], v[164:167], v[108:111]
    ds_read_b128 v[184:187], v238 offset:0
    s_waitcnt lgkmcnt(3)
    v_mfma_f32_16x16x32_bf16 v[112:115], v[192:195], v[152:155], v[112:115]
    v_mfma_f32_16x16x32_bf16 v[116:119], v[192:195], v[156:159], v[116:119]
    v_mfma_f32_16x16x32_bf16 v[120:123], v[192:195], v[160:163], v[120:123]
    v_mfma_f32_16x16x32_bf16 v[124:127], v[192:195], v[164:167], v[124:127]
    ds_read_b128 v[188:191], v238 offset:2048
    s_waitcnt lgkmcnt(3)
    v_mfma_f32_16x16x32_bf16 v[128:131], v[196:199], v[152:155], v[128:131]
    v_mfma_f32_16x16x32_bf16 v[132:135], v[196:199], v[156:159], v[132:135]
    v_mfma_f32_16x16x32_bf16 v[136:139], v[196:199], v[160:163], v[136:139]
    v_mfma_f32_16x16x32_bf16 v[140:143], v[196:199], v[164:167], v[140:143]
    ds_read_b128 v[192:195], v238 offset:4096
    s_waitcnt lgkmcnt(3)
    v_mfma_f32_16x16x32_bf16 v[144:147], v[200:203], v[152:155], v[144:147]
    v_mfma_f32_16x16x32_bf16 v[148:151], v[200:203], v[156:159], v[148:151]
    ds_read_b128 v[196:199], v238 offset:6144
    s_waitcnt lgkmcnt(3)
    v_mfma_f32_16x16x32_bf16 v[0:3], v[184:187], v[168:171], v[0:3]
    v_mfma_f32_16x16x32_bf16 v[4:7], v[184:187], v[172:175], v[4:7]
    v_mfma_f32_16x16x32_bf16 v[8:11], v[184:187], v[176:179], v[8:11]
    v_mfma_f32_16x16x32_bf16 v[12:15], v[184:187], v[180:183], v[12:15]
    ds_read_b128 v[200:203], v238 offset:8192
    s_waitcnt lgkmcnt(3)
    v_mfma_f32_16x16x32_bf16 v[16:19], v[188:191], v[168:171], v[16:19]
    v_mfma_f32_16x16x32_bf16 v[20:23], v[188:191], v[172:175], v[20:23]
    v_mfma_f32_16x16x32_bf16 v[24:27], v[188:191], v[176:179], v[24:27]
    v_mfma_f32_16x16x32_bf16 v[28:31], v[188:191], v[180:183], v[28:31]
    ds_read_b128 v[184:187], v238 offset:10240
    s_waitcnt lgkmcnt(3)
    v_mfma_f32_16x16x32_bf16 v[32:35], v[192:195], v[168:171], v[32:35]
    v_mfma_f32_16x16x32_bf16 v[36:39], v[192:195], v[172:175], v[36:39]
    v_mfma_f32_16x16x32_bf16 v[40:43], v[192:195], v[176:179], v[40:43]
    v_mfma_f32_16x16x32_bf16 v[44:47], v[192:195], v[180:183], v[44:47]
    ds_read_b128 v[188:191], v238 offset:12288
    s_waitcnt lgkmcnt(3)
    v_mfma_f32_16x16x32_bf16 v[48:51], v[196:199], v[168:171], v[48:51]
    v_mfma_f32_16x16x32_bf16 v[52:55], v[196:199], v[172:175], v[52:55]
    v_mfma_f32_16x16x32_bf16 v[56:59], v[196:199], v[176:179], v[56:59]
    v_mfma_f32_16x16x32_bf16 v[60:63], v[196:199], v[180:183], v[60:63]
    ds_read_b128 v[192:195], v238 offset:14336
    s_waitcnt lgkmcnt(3)
    v_mfma_f32_16x16x32_bf16 v[64:67], v[200:203], v[168:171], v[64:67]
    v_mfma_f32_16x16x32_bf16 v[68:71], v[200:203], v[172:175], v[68:71]
    v_mfma_f32_16x16x32_bf16 v[72:75], v[200:203], v[176:179], v[72:75]
    v_mfma_f32_16x16x32_bf16 v[76:79], v[200:203], v[180:183], v[76:79]
    ds_read_b128 v[196:199], v238 offset:16384
    s_waitcnt lgkmcnt(3)
    v_mfma_f32_16x16x32_bf16 v[80:83], v[184:187], v[168:171], v[80:83]
    v_mfma_f32_16x16x32_bf16 v[84:87], v[184:187], v[172:175], v[84:87]
    v_mfma_f32_16x16x32_bf16 v[88:91], v[184:187], v[176:179], v[88:91]
    v_mfma_f32_16x16x32_bf16 v[92:95], v[184:187], v[180:183], v[92:95]
    ds_read_b128 v[200:203], v229 offset:0
    s_waitcnt lgkmcnt(3)
    v_mfma_f32_16x16x32_bf16 v[96:99], v[188:191], v[168:171], v[96:99]
    v_mfma_f32_16x16x32_bf16 v[100:103], v[188:191], v[172:175], v[100:103]
    v_mfma_f32_16x16x32_bf16 v[104:107], v[188:191], v[176:179], v[104:107]
    v_mfma_f32_16x16x32_bf16 v[108:111], v[188:191], v[180:183], v[108:111]
    s_waitcnt lgkmcnt(0)
    s_barrier
    v_add_u32 v230, s72, v230
    v_add_u32 v231, s72, v231
    v_add_u32 v228, s73, v228
    v_add_u32 v229, s73, v229
    s_sub_i32 s72, 0, s72
    s_sub_i32 s73, 0, s73
    s_add_u32 s74, s74, 36864
    s_cmp_eq_u32 s74, 110592
    s_cselect_b32 s74, 0, s74
    ds_read_b128 v[152:155], v230 offset:0
    ds_read_b128 v[156:159], v230 offset:1024
    ds_read_b128 v[160:163], v231 offset:0
    ds_read_b128 v[164:167], v231 offset:1024
    v_add_u32 v237, s74, v226
    v_add_u32 v238, s74, v227
    ds_read_b128 v[184:187], v237 offset:0
    v_mfma_f32_16x16x32_bf16 v[112:115], v[192:195], v[168:171], v[112:115]
    v_mfma_f32_16x16x32_bf16 v[116:119], v[192:195], v[172:175], v[116:119]
    v_mfma_f32_16x16x32_bf16 v[120:123], v[192:195], v[176:179], v[120:123]
    v_mfma_f32_16x16x32_bf16 v[124:127], v[192:195], v[180:183], v[124:127]
    ds_read_b128 v[188:191], v237 offset:2048
    v_mfma_f32_16x16x32_bf16 v[128:131], v[196:199], v[168:171], v[128:131]
    v_mfma_f32_16x16x32_bf16 v[132:135], v[196:199], v[172:175], v[132:135]
    v_mfma_f32_16x16x32_bf16 v[136:139], v[196:199], v[176:179], v[136:139]
    v_mfma_f32_16x16x32_bf16 v[140:143], v[196:199], v[180:183], v[140:143]
    ds_read_b128 v[192:195], v237 offset:4096
    v_mfma_f32_16x16x32_bf16 v[144:147], v[200:203], v[168:171], v[144:147]
    v_mfma_f32_16x16x32_bf16 v[148:151], v[200:203], v[172:175], v[148:151]
    s_sub_u32 s75, s75, 1
    s_cmp_lg_u32 s75, 0
    s_cbranch_scc1 L_cloop
    ds_read_b128 v[196:199], v238 offset:0
    ds_read_b128 v[168:171], v230 offset:8192
    ds_read_b128 v[172:175], v230 offset:9216
    ds_read_b128 v[176:179], v231 offset:8192
    ds_read_b128 v[180:183], v231 offset:9216
    s_waitcnt lgkmcnt(7)
    v_mfma_f32_16x16x32_bf16 v[0:3], v[184:187], v[152:155], v[0:3]
    v_mfma_f32_16x16x32_bf16 v[4:7], v[184:187], v[156:159], v[4:7]
    v_mfma_f32_16x16x32_bf16 v[8:11], v[184:187], v[160:163], v[8:11]
    v_mfma_f32_16x16x32_bf16 v[12:15], v[184:187], v[164:167], v[12:15]
    ds_read_b128 v[200:203], v238 offset:2048
    s_waitcnt lgkmcnt(7)
    v_mfma_f32_16x16x32_bf16 v[16:19], v[188:191], v[152:155], v[16:19]
    v_mfma_f32_16x16x32_bf16 v[20:23], v[188:191], v[156:159], v[20:23]
    v_mfma_f32_16x16x32_bf16 v[24:27], v[188:191], v[160:163], v[24:27]
    v_mfma_f32_16x16x32_bf16 v[28:31], v[188:191], v[164:167], v[28:31]
    ds_read_b128 v[184:187], v238 offset:4096
    s_waitcnt lgkmcnt(7)
    v_mfma_f32_16x16x32_bf16 v[32:35], v[192:195], v[152:155], v[32:35]
    v_mfma_f32_16x16x32_bf16 v[36:39], v[192:195], v[156:159], v[36:39]
    v_mfma_f32_16x16x32_bf16 v[40:43], v[192:195], v[160:163], v[40:43]
    v_mfma_f32_16x16x32_bf16 v[44:47], v[192:195], v[164:167], v[44:47]
    ds_read_b128 v[188:191], v228 offset:0
    s_waitcnt lgkmcnt(3)
    v_mfma_f32_16x16x32_bf16 v[0:3], v[196:199], v[168:171], v[0:3]
    v_mfma_f32_16x16x32_bf16 v[4:7], v[196:199], v[172:175], v[4:7]
    v_mfma_f32_16x16x32_bf16 v[8:11], v[196:199], v[176:179], v[8:11]
    v_mfma_f32_16x16x32_bf16 v[12:15], v[196:199], v[180:183], v[12:15]
    ds_read_b128 v[192:195], v229 offset:0
    s_waitcnt lgkmcnt(3)
    v_mfma_f32_16x16x32_bf16 v[16:19], v[200:203], v[168:171], v[16:19]
    v_mfma_f32_16x16x32_bf16 v[20:23], v[200:203], v[172:175], v[20:23]
    v_mfma_f32_16x16x32_bf16 v[24:27], v[200:203], v[176:179], v[24:27]
    v_mfma_f32_16x16x32_bf16 v[28:31], v[200:203], v[180:183], v[28:31]
    ds_read_b128 v[196:199], v237 offset:6144
    s_waitcnt lgkmcnt(3)
    v_mfma_f32_16x16x32_bf16 v[32:35], v[184:187], v[168:171], v[32:35]
    v_pk_mul_f32 v[0:1], v[0:1], v[204:205] op_sel_hi:[1,0]
    v_pk_mul_f32 v[2:3], v[2:3], v[204:205] op_sel_hi:[1,0]
    v_pk_mul_f32 v[4:5], v[4:5], v[204:205] op_sel:[0,1] op_sel_hi:[1,1]
    v_pk_mul_f32 v[6:7], v[6:7], v[204:205] op_sel:[0,1] op_sel_hi:[1,1]
    s_nop 1
    v_mfma_f32_16x16x32_bf16 v[36:39], v[184:187], v[172:175], v[36:39]
    v_pk_mul_f32 v[8:9], v[8:9], v[206:207] op_sel_hi:[1,0]
    v_pk_mul_f32 v[10:11], v[10:11], v[206:207] op_sel_hi:[1,0]
    v_pk_mul_f32 v[12:13], v[12:13], v[206:207] op_sel:[0,1] op_sel_hi:[1,1]
    v_pk_mul_f32 v[14:15], v[14:15], v[206:207] op_sel:[0,1] op_sel_hi:[1,1]
    s_nop 1
    v_mfma_f32_16x16x32_bf16 v[40:43], v[184:187], v[176:179], v[40:43]
    v_cvt_pk_bf16_f32 v210, v0, v4
    v_cvt_pk_bf16_f32 v211, v8, v12
    v_cvt_pk_bf16_f32 v212, v1, v5
    v_cvt_pk_bf16_f32 v213, v9, v13
    v_mfma_f32_16x16x32_bf16 v[44:47], v[184:187], v[180:183], v[44:47]
    v_cvt_pk_bf16_f32 v214, v2, v6
    v_cvt_pk_bf16_f32 v215, v10, v14
    v_cvt_pk_bf16_f32 v216, v3, v7
    v_cvt_pk_bf16_f32 v217, v11, v15
    ds_read_b128 v[200:203], v238 offset:6144
    s_waitcnt lgkmcnt(3)
    v_mfma_f32_16x16x32_bf16 v[144:147], v[188:191], v[152:155], v[144:147]
    s_mov_b64 exec, s[58:59]
    v_swap_b32 v210, v211
    v_swap_b32 v212, v213
    v_swap_b32 v214, v215
    v_swap_b32 v216, v217
    s_mov_b64 exec, -1
    s_add_u32 s66, s41, 0
    buffer_store_dwordx2 v[210:211], v232, s[24:27], s66 offen nt
    buffer_store_dwordx2 v[212:213], v233, s[24:27], s66 offen nt
    v_mfma_f32_16x16x32_bf16 v[148:151], v[188:191], v[156:159], v[148:151]
    buffer_store_dwordx2 v[214:215], v234, s[24:27], s66 offen nt
    buffer_store_dwordx2 v[216:217], v235, s[24:27], s66 offen nt
    v_pk_mul_f32 v[16:17], v[16:17], v[204:205] op_sel_hi:[1,0]
    v_pk_mul_f32 v[18:19], v[18:19], v[204:205] op_sel_hi:[1,0]
    ds_read_b128 v[184:187], v237 offset:8192
    s_waitcnt lgkmcnt(3)
    v_mfma_f32_16x16x32_bf16 v[144:147], v[192:195], v[168:171], v[144:147]
    v_pk_mul_f32 v[20:21], v[20:21], v[204:205] op_sel:[0,1] op_sel_hi:[1,1]
    v_pk_mul_f32 v[22:23], v[22:23], v[204:205] op_sel:[0,1] op_sel_hi:[1,1]
    v_pk_mul_f32 v[24:25], v[24:25], v[206:207] op_sel_hi:[1,0]
    v_pk_mul_f32 v[26:27], v[26:27], v[206:207] op_sel_hi:[1,0]
    s_nop 1
    v_mfma_f32_16x16x32_bf16 v[148:151], v[192:195], v[172:175], v[148:151]
    v_pk_mul_f32 v[28:29], v[28:29], v[206:207] op_sel:[0,1] op_sel_hi:[1,1]
    v_pk_mul_f32 v[30:31], v[30:31], v[206:207] op_sel:[0,1] op_sel_hi:[1,1]
    v_cvt_pk_bf16_f32 v218, v16, v20
    v_cvt_pk_bf16_f32 v219, v24, v28
    ds_read_b128 v[188:191], v238 offset:8192
    s_waitcnt lgkmcnt(3)
    v_mfma_f32_16x16x32_bf16 v[48:51], v[196:199], v[152:155], v[48:51]
    v_cvt_pk_bf16_f32 v220, v17, v21
    v_cvt_pk_bf16_f32 v221, v25, v29
    v_cvt_pk_bf16_f32 v222, v18, v22
    v_cvt_pk_bf16_f32 v223, v26, v30
    v_mfma_f32_16x16x32_bf16 v[52:55], v[196:199], v[156:159], v[52:55]
    v_cvt_pk_bf16_f32 v224, v19, v23
    v_cvt_pk_bf16_f32 v225, v27, v31
    s_mov_b64 exec, s[58:59]
    v_swap_b32 v218, v219
    v_swap_b32 v220, v221
    v_swap_b32 v222, v223
    v_swap_b32 v224, v225
    s_mov_b64 exec, -1
    s_add_u32 s66, s41, 147456
    v_mfma_f32_16x16x32_bf16 v[56:59], v[196:199], v[160:163], v[56:59]
    buffer_store_dwordx2 v[218:219], v232, s[24:27], s66 offen nt
    buffer_store_dwordx2 v[220:221], v233, s[24:27], s66 offen nt
    buffer_store_dwordx2 v[222:223], v234, s[24:27], s66 offen nt
    buffer_store_dwordx2 v[224:225], v235, s[24:27], s66 offen nt
    v_mfma_f32_16x16x32_bf16 v[60:63], v[196:199], v[164:167], v[60:63]
    v_pk_mul_f32 v[32:33], v[32:33], v[204:205] op_sel_hi:[1,0]
    v_pk_mul_f32 v[34:35], v[34:35], v[204:205] op_sel_hi:[1,0]
    v_pk_mul_f32 v[36:37], v[36:37], v[204:205] op_sel:[0,1] op_sel_hi:[1,1]
    v_pk_mul_f32 v[38:39], v[38:39], v[204:205] op_sel:[0,1] op_sel_hi:[1,1]
    ds_read_b128 v[192:195], v237 offset:10240
    s_waitcnt lgkmcnt(3)
    v_mfma_f32_16x16x32_bf16 v[48:51], v[200:203], v[168:171], v[48:51]
    v_pk_mul_f32 v[40:41], v[40:41], v[206:207] op_sel_hi:[1,0]
    v_pk_mul_f32 v[42:43], v[42:43], v[206:207] op_sel_hi:[1,0]
    v_pk_mul_f32 v[44:45], v[44:45], v[206:207] op_sel:[0,1] op_sel_hi:[1,1]
    v_pk_mul_f32 v[46:47], v[46:47], v[206:207] op_sel:[0,1] op_sel_hi:[1,1]
    s_nop 1
    v_mfma_f32_16x16x32_bf16 v[52:55], v[200:203], v[172:175], v[52:55]
    v_cvt_pk_bf16_f32 v210, v32, v36
    v_cvt_pk_bf16_f32 v211, v40, v44
    v_cvt_pk_bf16_f32 v212, v33, v37
    v_cvt_pk_bf16_f32 v213, v41, v45
    v_mfma_f32_16x16x32_bf16 v[56:59], v[200:203], v[176:179], v[56:59]
    v_cvt_pk_bf16_f32 v214, v34, v38
    v_cvt_pk_bf16_f32 v215, v42, v46
    v_cvt_pk_bf16_f32 v216, v35, v39
    v_cvt_pk_bf16_f32 v217, v43, v47
    v_mfma_f32_16x16x32_bf16 v[60:63], v[200:203], v[180:183], v[60:63]
    s_mov_b64 exec, s[58:59]
    v_swap_b32 v210, v211
    v_swap_b32 v212, v213
    v_swap_b32 v214, v215
    v_swap_b32 v216, v217
    s_mov_b64 exec, -1
    s_add_u32 s66, s41, 294912
    buffer_store_dwordx2 v[210:211], v232, s[24:27], s66 offen nt
    buffer_store_dwordx2 v[212:213], v233, s[24:27], s66 offen nt
    ds_read_b128 v[196:199], v238 offset:10240
    s_waitcnt lgkmcnt(3)
    v_mfma_f32_16x16x32_bf16 v[64:67], v[184:187], v[152:155], v[64:67]
    buffer_store_dwordx2 v[214:215], v234, s[24:27], s66 offen nt
    buffer_store_dwordx2 v[216:217], v235, s[24:27], s66 offen nt
    v_mfma_f32_16x16x32_bf16 v[68:71], v[184:187], v[156:159], v[68:71]
    v_mfma_f32_16x16x32_bf16 v[72:75], v[184:187], v[160:163], v[72:75]
    v_mfma_f32_16x16x32_bf16 v[76:79], v[184:187], v[164:167], v[76:79]
    ds_read_b128 v[200:203], v237 offset:12288
    s_waitcnt lgkmcnt(3)
    v_mfma_f32_16x16x32_bf16 v[64:67], v[188:191], v[168:171], v[64:67]
    v_pk_mul_f32 v[48:49], v[48:49], v[204:205] op_sel_hi:[1,0]
    v_pk_mul_f32 v[50:51], v[50:51], v[204:205] op_sel_hi:[1,0]
    v_pk_mul_f32 v[52:53], v[52:53], v[204:205] op_sel:[0,1] op_sel_hi:[1,1]
    v_pk_mul_f32 v[54:55], v[54:55], v[204:205] op_sel:[0,1] op_sel_hi:[1,1]
    s_nop 1
    v_mfma_f32_16x16x32_bf16 v[68:71], v[188:191], v[172:175], v[68:71]
    v_pk_mul_f32 v[56:57], v[56:57], v[206:207] op_sel_hi:[1,0]
    v_pk_mul_f32 v[58:59], v[58:59], v[206:207] op_sel_hi:[1,0]
    v_pk_mul_f32 v[60:61], v[60:61], v[206:207] op_sel:[0,1] op_sel_hi:[1,1]
    v_pk_mul_f32 v[62:63], v[62:63], v[206:207] op_sel:[0,1] op_sel_hi:[1,1]
    s_nop 1
    v_mfma_f32_16x16x32_bf16 v[72:75], v[188:191], v[176:179], v[72:75]
    v_cvt_pk_bf16_f32 v218, v48, v52
    v_cvt_pk_bf16_f32 v219, v56, v60
    v_cvt_pk_bf16_f32 v220, v49, v53
    v_cvt_pk_bf16_f32 v221, v57, v61
    v_mfma_f32_16x16x32_bf16 v[76:79], v[188:191], v[180:183], v[76:79]
    v_cvt_pk_bf16_f32 v222, v50, v54
    v_cvt_pk_bf16_f32 v223, v58, v62
    v_cvt_pk_bf16_f32 v224, v51, v55
    v_cvt_pk_bf16_f32 v225, v59, v63
    ds_read_b128 v[184:187], v238 offset:12288
    s_waitcnt lgkmcnt(3)
    v_mfma_f32_16x16x32_bf16 v[80:83], v[192:195], v[152:155], v[80:83]
    s_mov_b64 exec, s[58:59]
    v_swap_b32 v218, v219
    v_swap_b32 v220, v221
    v_swap_b32 v222, v223
    v_swap_b32 v224, v225
    s_mov_b64 exec, -1
    s_add_u32 s66, s41, 442368
    buffer_store_dwordx2 v[218:219], v232, s[24:27], s66 offen nt
    buffer_store_dwordx2 v[220:221], v233, s[24:27], s66 offen nt
    v_mfma_f32_16x16x32_bf16 v[84:87], v[192:195], v[156:159], v[84:87]
    buffer_store_dwordx2 v[222:223], v234, s[24:27], s66 offen nt
    buffer_store_dwordx2 v[224:225], v235, s[24:27], s66 offen nt
    v_mfma_f32_16x16x32_bf16 v[88:91], v[192:195], v[160:163], v[88:91]
    v_mfma_f32_16x16x32_bf16 v[92:95], v[192:195], v[164:167], v[92:95]
    ds_read_b128 v[188:191], v237 offset:14336
    s_waitcnt lgkmcnt(3)
    v_mfma_f32_16x16x32_bf16 v[80:83], v[196:199], v[168:171], v[80:83]
    v_pk_mul_f32 v[64:65], v[64:65], v[204:205] op_sel_hi:[1,0]
    v_pk_mul_f32 v[66:67], v[66:67], v[204:205] op_sel_hi:[1,0]
    v_pk_mul_f32 v[68:69], v[68:69], v[204:205] op_sel:[0,1] op_sel_hi:[1,1]
    v_pk_mul_f32 v[70:71], v[70:71], v[204:205] op_sel:[0,1] op_sel_hi:[1,1]
    s_nop 1
    v_mfma_f32_16x16x32_bf16 v[84:87], v[196:199], v[172:175], v[84:87]
    v_pk_mul_f32 v[72:73], v[72:73], v[206:207] op_sel_hi:[1,0]
    v_pk_mul_f32 v[74:75], v[74:75], v[206:207] op_sel_hi:[1,0]
    v_pk_mul_f32 v[76:77], v[76:77], v[206:207] op_sel:[0,1] op_sel_hi:[1,1]
    v_pk_mul_f32 v[78:79], v[78:79], v[206:207] op_sel:[0,1] op_sel_hi:[1,1]
    s_nop 1
    v_mfma_f32_16x16x32_bf16 v[88:91], v[196:199], v[176:179], v[88:91]
    v_cvt_pk_bf16_f32 v210, v64, v68
    v_cvt_pk_bf16_f32 v211, v72, v76
    v_cvt_pk_bf16_f32 v212, v65, v69
    v_cvt_pk_bf16_f32 v213, v73, v77
    v_mfma_f32_16x16x32_bf16 v[92:95], v[196:199], v[180:183], v[92:95]
    v_cvt_pk_bf16_f32 v214, v66, v70
    v_cvt_pk_bf16_f32 v215, v74, v78
    v_cvt_pk_bf16_f32 v216, v67, v71
    v_cvt_pk_bf16_f32 v217, v75, v79
    ds_read_b128 v[192:195], v238 offset:14336
    s_waitcnt lgkmcnt(3)
    v_mfma_f32_16x16x32_bf16 v[96:99], v[200:203], v[152:155], v[96:99]
    s_mov_b64 exec, s[58:59]
    v_swap_b32 v210, v211
    v_swap_b32 v212, v213
    v_swap_b32 v214, v215
    v_swap_b32 v216, v217
    s_mov_b64 exec, -1
    s_add_u32 s66, s41, 589824
    buffer_store_dwordx2 v[210:211], v232, s[24:27], s66 offen nt
    buffer_store_dwordx2 v[212:213], v233, s[24:27], s66 offen nt
    v_mfma_f32_16x16x32_bf16 v[100:103], v[200:203], v[156:159], v[100:103]
    buffer_store_dwordx2 v[214:215], v234, s[24:27], s66 offen nt
    buffer_store_dwordx2 v[216:217], v235, s[24:27], s66 offen nt
    v_mfma_f32_16x16x32_bf16 v[104:107], v[200:203], v[160:163], v[104:107]
    v_mfma_f32_16x16x32_bf16 v[108:111], v[200:203], v[164:167], v[108:111]
    ds_read_b128 v[196:199], v237 offset:16384
    s_waitcnt lgkmcnt(3)
    v_mfma_f32_16x16x32_bf16 v[96:99], v[184:187], v[168:171], v[96:99]
    v_pk_mul_f32 v[80:81], v[80:81], v[204:205] op_sel_hi:[1,0]
    v_pk_mul_f32 v[82:83], v[82:83], v[204:205] op_sel_hi:[1,0]
    v_pk_mul_f32 v[84:85], v[84:85], v[204:205] op_sel:[0,1] op_sel_hi:[1,1]
    v_pk_mul_f32 v[86:87], v[86:87], v[204:205] op_sel:[0,1] op_sel_hi:[1,1]
    s_nop 1
    v_mfma_f32_16x16x32_bf16 v[100:103], v[184:187], v[172:175], v[100:103]
    v_pk_mul_f32 v[88:89], v[88:89], v[206:207] op_sel_hi:[1,0]
    v_pk_mul_f32 v[90:91], v[90:91], v[206:207] op_sel_hi:[1,0]
    v_pk_mul_f32 v[92:93], v[92:93], v[206:207] op_sel:[0,1] op_sel_hi:[1,1]
    v_pk_mul_f32 v[94:95], v[94:95], v[206:207] op_sel:[0,1] op_sel_hi:[1,1]
    s_nop 1
    v_mfma_f32_16x16x32_bf16 v[104:107], v[184:187], v[176:179], v[104:107]
    v_cvt_pk_bf16_f32 v218, v80, v84
    v_cvt_pk_bf16_f32 v219, v88, v92
    v_cvt_pk_bf16_f32 v220, v81, v85
    v_cvt_pk_bf16_f32 v221, v89, v93
    v_mfma_f32_16x16x32_bf16 v[108:111], v[184:187], v[180:183], v[108:111]
    v_cvt_pk_bf16_f32 v222, v82, v86
    v_cvt_pk_bf16_f32 v223, v90, v94
    v_cvt_pk_bf16_f32 v224, v83, v87
    v_cvt_pk_bf16_f32 v225, v91, v95
    ds_read_b128 v[200:203], v238 offset:16384
    s_waitcnt lgkmcnt(3)
    v_mfma_f32_16x16x32_bf16 v[112:115], v[188:191], v[152:155], v[112:115]
    s_mov_b64 exec, s[58:59]
    v_swap_b32 v218, v219
    v_swap_b32 v220, v221
    v_swap_b32 v222, v223
    v_swap_b32 v224, v225
    s_mov_b64 exec, -1
    s_add_u32 s66, s41, 737280
    buffer_store_dwordx2 v[218:219], v232, s[24:27], s66 offen nt
    buffer_store_dwordx2 v[220:221], v233, s[24:27], s66 offen nt
    v_mfma_f32_16x16x32_bf16 v[116:119], v[188:191], v[156:159], v[116:119]
    buffer_store_dwordx2 v[222:223], v234, s[24:27], s66 offen nt
    buffer_store_dwordx2 v[224:225], v235, s[24:27], s66 offen nt
    v_mfma_f32_16x16x32_bf16 v[120:123], v[188:191], v[160:163], v[120:123]
    v_mfma_f32_16x16x32_bf16 v[124:127], v[188:191], v[164:167], v[124:127]
    s_waitcnt lgkmcnt(2)
    v_mfma_f32_16x16x32_bf16 v[112:115], v[192:195], v[168:171], v[112:115]
    v_pk_mul_f32 v[96:97], v[96:97], v[204:205] op_sel_hi:[1,0]
    v_pk_mul_f32 v[98:99], v[98:99], v[204:205] op_sel_hi:[1,0]
    v_pk_mul_f32 v[100:101], v[100:101], v[204:205] op_sel:[0,1] op_sel_hi:[1,1]
    v_pk_mul_f32 v[102:103], v[102:103], v[204:205] op_sel:[0,1] op_sel_hi:[1,1]
    s_nop 1
    v_mfma_f32_16x16x32_bf16 v[116:119], v[192:195], v[172:175], v[116:119]
    v_pk_mul_f32 v[104:105], v[104:105], v[206:207] op_sel_hi:[1,0]
    v_pk_mul_f32 v[106:107], v[106:107], v[206:207] op_sel_hi:[1,0]
    v_pk_mul_f32 v[108:109], v[108:109], v[206:207] op_sel:[0,1] op_sel_hi:[1,1]
    v_pk_mul_f32 v[110:111], v[110:111], v[206:207] op_sel:[0,1] op_sel_hi:[1,1]
    s_nop 1
    v_mfma_f32_16x16x32_bf16 v[120:123], v[192:195], v[176:179], v[120:123]
    v_cvt_pk_bf16_f32 v210, v96, v100
    v_cvt_pk_bf16_f32 v211, v104, v108
    v_cvt_pk_bf16_f32 v212, v97, v101
    v_cvt_pk_bf16_f32 v213, v105, v109
    v_mfma_f32_16x16x32_bf16 v[124:127], v[192:195], v[180:183], v[124:127]
    v_cvt_pk_bf16_f32 v214, v98, v102
    v_cvt_pk_bf16_f32 v215, v106, v110
    v_cvt_pk_bf16_f32 v216, v99, v103
    v_cvt_pk_bf16_f32 v217, v107, v111
    s_waitcnt lgkmcnt(1)
    v_mfma_f32_16x16x32_bf16 v[128:131], v[196:199], v[152:155], v[128:131]
    s_mov_b64 exec, s[58:59]
    v_swap_b32 v210, v211
    v_swap_b32 v212, v213
    v_swap_b32 v214, v215
    v_swap_b32 v216, v217
    s_mov_b64 exec, -1
    s_add_u32 s66, s41, 884736
    buffer_store_dwordx2 v[210:211], v232, s[24:27], s66 offen nt
    buffer_store_dwordx2 v[212:213], v233, s[24:27], s66 offen nt
    v_mfma_f32_16x16x32_bf16 v[132:135], v[196:199], v[156:159], v[132:135]
    buffer_store_dwordx2 v[214:215], v234, s[24:27], s66 offen nt
    buffer_store_dwordx2 v[216:217], v235, s[24:27], s66 offen nt
    v_mfma_f32_16x16x32_bf16 v[136:139], v[196:199], v[160:163], v[136:139]
    v_mfma_f32_16x16x32_bf16 v[140:143], v[196:199], v[164:167], v[140:143]
    s_waitcnt lgkmcnt(0)
    v_mfma_f32_16x16x32_bf16 v[128:131], v[200:203], v[168:171], v[128:131]
    v_pk_mul_f32 v[112:113], v[112:113], v[204:205] op_sel_hi:[1,0]
    v_pk_mul_f32 v[114:115], v[114:115], v[204:205] op_sel_hi:[1,0]
    v_pk_mul_f32 v[116:117], v[116:117], v[204:205] op_sel:[0,1] op_sel_hi:[1,1]
    v_pk_mul_f32 v[118:119], v[118:119], v[204:205] op_sel:[0,1] op_sel_hi:[1,1]
    s_nop 1
    v_mfma_f32_16x16x32_bf16 v[132:135], v[200:203], v[172:175], v[132:135]
    v_pk_mul_f32 v[120:121], v[120:121], v[206:207] op_sel_hi:[1,0]
    v_pk_mul_f32 v[122:123], v[122:123], v[206:207] op_sel_hi:[1,0]
    v_pk_mul_f32 v[124:125], v[124:125], v[206:207] op_sel:[0,1] op_sel_hi:[1,1]
    v_pk_mul_f32 v[126:127], v[126:127], v[206:207] op_sel:[0,1] op_sel_hi:[1,1]
    s_nop 1
    v_mfma_f32_16x16x32_bf16 v[136:139], v[200:203], v[176:179], v[136:139]
    v_cvt_pk_bf16_f32 v218, v112, v116
    v_cvt_pk_bf16_f32 v219, v120, v124
    v_cvt_pk_bf16_f32 v220, v113, v117
    v_cvt_pk_bf16_f32 v221, v121, v125
    v_mfma_f32_16x16x32_bf16 v[140:143], v[200:203], v[180:183], v[140:143]
    v_cvt_pk_bf16_f32 v222, v114, v118
    v_cvt_pk_bf16_f32 v223, v122, v126
    v_cvt_pk_bf16_f32 v224, v115, v119
    v_cvt_pk_bf16_f32 v225, v123, v127
    s_mov_b64 exec, s[58:59]
    v_swap_b32 v218, v219
    v_swap_b32 v220, v221
    v_swap_b32 v222, v223
    v_swap_b32 v224, v225
    s_mov_b64 exec, -1
    s_add_u32 s66, s41, 1032192
    buffer_store_dwordx2 v[218:219], v232, s[24:27], s66 offen nt
    buffer_store_dwordx2 v[220:221], v233, s[24:27], s66 offen nt
    buffer_store_dwordx2 v[222:223], v234, s[24:27], s66 offen nt
    buffer_store_dwordx2 v[224:225], v235, s[24:27], s66 offen nt
    s_cmp_lt_u32 s37, 2
    s_cbranch_scc0 L_c_nosh
    v_pk_mul_f32 v[144:145], v[144:145], v[204:205] op_sel_hi:[1,0]
    v_pk_mul_f32 v[146:147], v[146:147], v[204:205] op_sel_hi:[1,0]
    v_pk_mul_f32 v[148:149], v[148:149], v[204:205] op_sel:[0,1] op_sel_hi:[1,1]
    v_pk_mul_f32 v[150:151], v[150:151], v[204:205] op_sel:[0,1] op_sel_hi:[1,1]
    v_cvt_pk_bf16_f32 v218, v144, v148
    v_cvt_pk_bf16_f32 v219, v145, v149
    v_cvt_pk_bf16_f32 v220, v146, v150
    v_cvt_pk_bf16_f32 v221, v147, v151
    buffer_store_dword v218, v232, s[24:27], s67 offen nt
    buffer_store_dword v219, v233, s[24:27], s67 offen nt
    buffer_store_dword v220, v234, s[24:27], s67 offen nt
    buffer_store_dword v221, v235, s[24:27], s67 offen nt
L_c_nosh:
    s_nop 7
    v_pk_mul_f32 v[128:129], v[128:129], v[204:205] op_sel_hi:[1,0]
    v_pk_mul_f32 v[130:131], v[130:131], v[204:205] op_sel_hi:[1,0]
    v_pk_mul_f32 v[132:133], v[132:133], v[204:205] op_sel:[0,1] op_sel_hi:[1,1]
    v_pk_mul_f32 v[134:135], v[134:135], v[204:205] op_sel:[0,1] op_sel_hi:[1,1]
    v_pk_mul_f32 v[136:137], v[136:137], v[206:207] op_sel_hi:[1,0]
    v_pk_mul_f32 v[138:139], v[138:139], v[206:207] op_sel_hi:[1,0]
    v_pk_mul_f32 v[140:141], v[140:141], v[206:207] op_sel:[0,1] op_sel_hi:[1,1]
    v_pk_mul_f32 v[142:143], v[142:143], v[206:207] op_sel:[0,1] op_sel_hi:[1,1]
    v_cvt_pk_bf16_f32 v210, v128, v132
    v_cvt_pk_bf16_f32 v211, v136, v140
    v_cvt_pk_bf16_f32 v212, v129, v133
    v_cvt_pk_bf16_f32 v213, v137, v141
    v_cvt_pk_bf16_f32 v214, v130, v134
    v_cvt_pk_bf16_f32 v215, v138, v142
    v_cvt_pk_bf16_f32 v216, v131, v135
    v_cvt_pk_bf16_f32 v217, v139, v143
    s_mov_b64 exec, s[58:59]
    v_swap_b32 v210, v211
    v_swap_b32 v212, v213
    v_swap_b32 v214, v215
    v_swap_b32 v216, v217
    s_mov_b64 exec, -1
    s_add_u32 s66, s41, 1179648
    buffer_store_dwordx2 v[210:211], v232, s[24:27], s66 offen nt
    buffer_store_dwordx2 v[212:213], v233, s[24:27], s66 offen nt
    buffer_store_dwordx2 v[214:215], v234, s[24:27], s66 offen nt
    buffer_store_dwordx2 v[216:217], v235, s[24:27], s66 offen nt
    s_endpgm
L_end:
    s_endpgm
.section .rodata,"a"
.p2align 6
.amdhsa_kernel standalone__normalfloat_lut_codebook_lookup__prompt_kernel
  .amdhsa_next_free_vgpr 256
  .amdhsa_next_free_sgpr 96
  .amdhsa_accum_offset 256
  .amdhsa_group_segment_fixed_size 0
  .amdhsa_kernarg_size 56
  .amdhsa_user_sgpr_count 2
  .amdhsa_user_sgpr_kernarg_segment_ptr 1
  .amdhsa_system_sgpr_workgroup_id_x 1
.end_amdhsa_kernel
```
